```python
import torch

def _softmax(x, axis=-1):
    return torch.softmax(x, dim=axis)
def _gelu(x):
    return torch.nn.functional.gelu(x, approximate="tanh")
def _silu(x):
    return torch.nn.functional.silu(x)
def _sigmoid(x):
    return torch.sigmoid(x)
def _layernorm(x, axis=-1, eps=1e-5):
    m = x.mean(dim=axis, keepdim=True)
    v = x.var(dim=axis, keepdim=True, unbiased=False)
    return (x - m) / torch.sqrt(v + eps)
def _scatter_add(tgt, idx, src, axis=0):
    return tgt.clone().index_add_(axis, idx, src)
def _segment_sum(src, seg, n):
    out = torch.zeros((n,) + src.shape[1:], dtype=src.dtype)
    return out.index_add_(0, seg, src)
def _pad(x, pw):
    flat = tuple(v for pair in reversed(pw) for v in pair)
    return torch.nn.functional.pad(x, flat)

kernel_name = 'standalone__kv_cache_quant_int4_int2_kv_with_per_channel_or_per_token_scales__sampling'

def setup_inputs():

    _w = (lambda a: (lambda t: t.to(torch.bfloat16) if t.is_floating_point() else t)(torch.as_tensor(a)))
    B = 8
    Sq = 16
    Skv = 8192
    Hq = 32
    Hkv = 8
    Dh = 128
    bits = 4
    G = 128
    if G <= 0 or G >= Skv:
        G = max(1, Skv // 2)
    Skv = (Skv // G) * G
    ngk = Skv // G
    qmax = (1 << bits) - 1
    return {
        "q": _w((lambda *s: torch.randn(*s, dtype=torch.bfloat16) * 1.6)(B, Hq, Sq, Dh)),
        "qk": _w(torch.randint(0, qmax + 1, (B, Hkv, Skv, Dh)).to(torch.int32)),
        "qv": _w(torch.randint(0, qmax + 1, (B, Hkv, Skv, Dh)).to(torch.int32)),
        "k_scales": _w(torch.abs((lambda *s: torch.randn(*s, dtype=torch.bfloat16) * 1.6)(B, Hkv, ngk, Dh)) * 0.05 + 0.02),
        "k_zeros": _w((lambda *s: torch.randn(*s, dtype=torch.bfloat16) * 1.6)(B, Hkv, ngk, Dh) + float(qmax) / 2.0),
        "v_scales": _w(torch.abs((lambda *s: torch.randn(*s, dtype=torch.bfloat16) * 0.05)(B, Hkv, Skv, 1)) * 0.05 + 0.02),
        "v_zeros": _w((lambda *s: torch.randn(*s, dtype=torch.bfloat16) * 0.05)(B, Hkv, Skv, 1) + float(qmax) / 2.0),
    }

def reference(q, qk, qv, k_scales, k_zeros, v_scales, v_zeros):
    B, Hq, Sq, Dh = q.shape
    Hkv, Skv = qk.shape[1], qk.shape[2]
    ngk = k_scales.shape[2]
    G = Skv // ngk
    ks = (lambda x, n, axis: torch.repeat_interleave(x, n, dim=axis))(k_scales, G, axis=2)
    kz = (lambda x, n, axis: torch.repeat_interleave(x, n, dim=axis))(k_zeros, G, axis=2)
    k = ((lambda x, dt: x.to(dt))(qk, q.dtype) - kz) * ks
    v = ((lambda x, dt: x.to(dt))(qv, q.dtype) - v_zeros) * v_scales
    rep = Hq // Hkv
    if rep > 1:
        k = (lambda x, n, axis: torch.repeat_interleave(x, n, dim=axis))(k, rep, axis=1)
        v = (lambda x, n, axis: torch.repeat_interleave(x, n, dim=axis))(v, rep, axis=1)
    scale = float(Dh) ** -0.5
    logits = torch.einsum("bhqd,bhkd->bhqk", q, k) * scale
    p = _softmax(logits, axis=-1)
    o = torch.einsum("bhqk,bhkd->bhqd", p, v)
    return o
```

```asm
; @launch grid=(256,1,1) block=(512,1,1) lds=163344
.amdgcn_target "amdgcn-amd-amdhsa--gfx950"
.text
.globl standalone__kv_cache_quant_int4_int2_kv_with_per_channel_or_per_token_scales__sampling_kernel
.p2align 8
.type standalone__kv_cache_quant_int4_int2_kv_with_per_channel_or_per_token_scales__sampling_kernel,@function
standalone__kv_cache_quant_int4_int2_kv_with_per_channel_or_per_token_scales__sampling_kernel:
    s_cmp_ge_u32 s2, 256
    s_cbranch_scc1 L_end
    s_load_dwordx16 s[4:19], s[0:1], 0
    s_load_dwordx4 s[20:23], s[0:1], 64
    v_lshrrev_b32 v1, 6, v0
    v_and_b32 v0, 63, v0
    v_readfirstlane_b32 s3, v1
    v_lshlrev_b32 v2, 7, v0
    s_lshr_b32 s47, s2, 4
    s_lshl_b32 s47, s47, 3
    s_or_b32 s47, s47, s3
    s_cmp_lg_u32 s47, 7
    s_cbranch_scc1 L_noEW
    s_getpc_b64 s[48:49]
L_ewref:
    v_add_u32 v3, 8192, v2
    v_min_u32 v3, L_end-L_ewref, v3
    global_load_dword v4, v2, s[48:49]
    global_load_dword v5, v3, s[48:49]
    s_waitcnt vmcnt(0)
L_noEW:
    s_and_b32 s40, s2, 7
    s_lshl_b32 s40, s40, 5
    s_lshr_b32 s41, s2, 3
    s_or_b32 s40, s40, s41
    s_lshr_b32 s41, s40, 2
    s_lshr_b32 s38, s2, 3
    s_and_b32 s38, s38, 1
    s_cmp_lg_u32 s3, 0
    s_cbranch_scc1 L_worker
    s_setprio 3
    v_lshlrev_b32 v16, 4, v0
    s_lshl_b32 s42, s40, 12
    v_add_u32 v17, s42, v16
    s_mov_b32 m0, 32768
    s_waitcnt lgkmcnt(0)
    global_load_lds_dwordx4 v17, s[10:11] offset:0 nt
    global_load_lds_dwordx4 v17, s[10:11] offset:1024 nt
    global_load_lds_dwordx4 v17, s[10:11] offset:2048 nt
    global_load_lds_dwordx4 v17, s[10:11] offset:3072 nt
    s_mov_b32 m0, 36864
    s_nop 0
    global_load_lds_dwordx4 v17, s[12:13] offset:0 nt
    global_load_lds_dwordx4 v17, s[12:13] offset:1024 nt
    global_load_lds_dwordx4 v17, s[12:13] offset:2048 nt
    global_load_lds_dwordx4 v17, s[12:13] offset:3072 nt
    s_mov_b32 m0, 40960
    s_nop 0
    global_load_lds_dwordx4 v17, s[14:15] offset:0 nt
    global_load_lds_dwordx4 v17, s[14:15] offset:1024 nt
    global_load_lds_dwordx4 v17, s[14:15] offset:2048 nt
    global_load_lds_dwordx4 v17, s[14:15] offset:3072 nt
    s_mov_b32 m0, 45056
    s_nop 0
    global_load_lds_dwordx4 v17, s[16:17] offset:0 nt
    global_load_lds_dwordx4 v17, s[16:17] offset:1024 nt
    global_load_lds_dwordx4 v17, s[16:17] offset:2048 nt
    global_load_lds_dwordx4 v17, s[16:17] offset:3072 nt
    v_lshrrev_b32 v1, 4, v0
    v_and_b32 v2, 15, v0
    v_xor_b32 v2, v2, v1
    v_lshlrev_b32 v2, 4, v2
    v_lshl_or_b32 v2, v1, 8, v2
    s_lshl_b32 s43, s41, 14
    v_add_u32 v20, s43, v2
    v_xor_b32 v21, 64, v20
    v_xor_b32 v22, 128, v20
    v_xor_b32 v23, 192, v20
    s_mov_b32 m0, 49152
    s_nop 0
    global_load_lds_dwordx4 v20, s[4:5] offset:0
    global_load_lds_dwordx4 v21, s[4:5] offset:1024
    global_load_lds_dwordx4 v22, s[4:5] offset:2048
    global_load_lds_dwordx4 v23, s[4:5] offset:3072
    s_add_u32 s4, s4, 4096
    s_addc_u32 s5, s5, 0
    s_mov_b32 m0, 53248
    s_nop 0
    global_load_lds_dwordx4 v20, s[4:5] offset:0
    global_load_lds_dwordx4 v21, s[4:5] offset:1024
    global_load_lds_dwordx4 v22, s[4:5] offset:2048
    global_load_lds_dwordx4 v23, s[4:5] offset:3072
    s_add_u32 s4, s4, 4096
    s_addc_u32 s5, s5, 0
    s_mov_b32 m0, 57344
    s_nop 0
    global_load_lds_dwordx4 v20, s[4:5] offset:0
    global_load_lds_dwordx4 v21, s[4:5] offset:1024
    global_load_lds_dwordx4 v22, s[4:5] offset:2048
    global_load_lds_dwordx4 v23, s[4:5] offset:3072
    s_add_u32 s4, s4, 4096
    s_addc_u32 s5, s5, 0
    s_mov_b32 m0, 61440
    s_nop 0
    global_load_lds_dwordx4 v20, s[4:5] offset:0
    global_load_lds_dwordx4 v21, s[4:5] offset:1024
    global_load_lds_dwordx4 v22, s[4:5] offset:2048
    global_load_lds_dwordx4 v23, s[4:5] offset:3072
    v_lshrrev_b32 v1, 5, v0
    v_and_b32 v2, 31, v0
    v_xor_b32 v2, v2, v1
    v_lshlrev_b32 v2, 4, v2
    v_lshl_or_b32 v8, v1, 9, v2
    s_and_b32 s37, s2, 112
    s_bcnt1_i32_b32 s37, s37
    s_lshl_b32 s37, s37, 1
    s_and_b32 s37, s37, 2
    s_and_b32 s36, s2, 136
    s_bcnt1_i32_b32 s36, s36
    s_and_b32 s36, s36, 1
    s_or_b32 s37, s37, s36
    s_lshl_b32 s32, s37, 12
    s_xor_b32 s33, s32, 4096
    s_xor_b32 s34, s32, 8192
    s_xor_b32 s35, s32, 12288
    v_xor_b32 v9, 32, v8
    v_xor_b32 v10, 64, v8
    v_xor_b32 v11, 96, v8
    v_xor_b32 v12, 128, v8
    v_xor_b32 v13, 160, v8
    v_xor_b32 v14, 192, v8
    v_xor_b32 v15, 224, v8
    s_lshl_b32 s42, s40, 20
    s_lshl_b32 s44, s38, 14
    s_mov_b32 s45, s44
    s_mov_b32 s46, 0
    s_mov_b32 s39, s44
    s_mov_b32 s50, 0
    s_add_u32 s24, s6, s42
    s_addc_u32 s25, s7, 0
    s_and_b32 s25, s25, 0xffff
    s_mov_b32 s26, 1048576
    s_mov_b32 s27, 0x20000
    s_add_u32 s28, s8, s42
    s_addc_u32 s29, s9, 0
    s_and_b32 s29, s29, 0xffff
    s_add_u32 m0, s46, 0
    s_add_u32 s48, s44, s32
    buffer_load_dwordx4 v8, s[24:27], s48 offen offset:0 nt lds
    buffer_load_dwordx4 v9, s[24:27], s48 offen offset:1024 nt lds
    buffer_load_dwordx4 v10, s[24:27], s48 offen offset:2048 nt lds
    buffer_load_dwordx4 v11, s[24:27], s48 offen offset:3072 nt lds
    s_add_u32 m0, s46, 4096
    s_add_u32 s48, s44, s33
    buffer_load_dwordx4 v12, s[24:27], s48 offen offset:0 nt lds
    buffer_load_dwordx4 v13, s[24:27], s48 offen offset:1024 nt lds
    buffer_load_dwordx4 v14, s[24:27], s48 offen offset:2048 nt lds
    buffer_load_dwordx4 v15, s[24:27], s48 offen offset:3072 nt lds
    s_add_u32 m0, s46, 8192
    s_add_u32 s48, s44, s34
    buffer_load_dwordx4 v8, s[24:27], s48 offen offset:0 nt lds
    buffer_load_dwordx4 v9, s[24:27], s48 offen offset:1024 nt lds
    buffer_load_dwordx4 v10, s[24:27], s48 offen offset:2048 nt lds
    buffer_load_dwordx4 v11, s[24:27], s48 offen offset:3072 nt lds
    s_add_u32 m0, s46, 12288
    s_add_u32 s48, s44, s35
    buffer_load_dwordx4 v12, s[24:27], s48 offen offset:0 nt lds
    s_xor_b32 s44, s44, s39
    s_add_u32 s44, s44, 16384
    s_xor_b32 s44, s44, s39
    buffer_load_dwordx4 v13, s[24:27], s48 offen offset:1024 nt lds
    s_add_u32 s46, s46, 16384
    s_and_b32 s46, s46, 65535
    buffer_load_dwordx4 v14, s[24:27], s48 offen offset:2048 nt lds
    s_add_u32 s50, s50, 1
    buffer_load_dwordx4 v15, s[24:27], s48 offen offset:3072 nt lds
    s_memrealtime s[78:79]
    v_xor_b32 v32, v8, v16
    v_xor_b32 v33, v9, v16
    v_xor_b32 v34, v10, v16
    v_xor_b32 v35, v11, v16
    v_xor_b32 v36, v12, v16
    v_xor_b32 v37, v13, v16
    v_xor_b32 v38, v14, v16
    v_xor_b32 v39, v15, v16
    s_mov_b32 s51, 22
    v_and_b32 v28, 15, v0
    v_mul_u32_u24 v28, 0x22100, v28
    v_add_u32 v28, 10485760, v28
    s_mov_b32 s84, 0
    s_mov_b32 s88, 0
    s_mov_b32 s89, 6944
    s_mov_b32 s52, 0
    s_mov_b32 s53, 0
    s_mov_b32 s54, 0
    s_mov_b32 s55, 160768
    s_lshr_b32 s87, s2, 7
    s_lshl_b32 s87, s87, 3
    s_and_b32 s47, s2, 7
    s_or_b32 s87, s87, s47
    s_mul_i32 s47, s87, 0x22100
    s_add_u32 s47, s47, 10485760
    v_lshl_add_u32 v27, v0, 2, s47
    s_lshr_b32 s47, s2, 3
    s_and_b32 s87, s47, 15
    s_cmp_eq_u32 s87, 5
    s_cselect_b32 s94, 0, 0
    s_add_u32 s94, s94, 160768
    s_mov_b32 s55, s94
    s_mov_b32 s58, 2
    s_mov_b32 s59, 6
    s_mov_b32 s57, 4
    s_mov_b32 s85, 0
    s_waitcnt lgkmcnt(0)
    s_mov_b32 s90, s78
    s_sub_u32 s78, s78, 300
    s_cmp_lg_u32 s87, 5
    s_cbranch_scc1 L_noPub0
    v_mov_b32 v30, s90
    s_mov_b32 exec_hi, 0
    global_store_dword v27, v30, s[22:23] sc1
    s_mov_b32 exec_hi, -1
L_noPub0:
    s_mov_b32 s56, 4
    s_mov_b32 s93, 19
    s_waitcnt vmcnt(32)
    s_barrier
    s_add_u32 m0, s46, 0
    s_add_u32 s48, s44, s32
    s_waitcnt vmcnt(26)
    buffer_load_dwordx4 v8, s[24:27], s48 offen offset:0 nt lds
    buffer_load_dwordx4 v9, s[24:27], s48 offen offset:1024 nt lds
    buffer_load_dwordx4 v10, s[24:27], s48 offen offset:2048 nt lds
    buffer_load_dwordx4 v11, s[24:27], s48 offen offset:3072 nt lds
    s_add_u32 m0, s46, 4096
    s_add_u32 s48, s44, s33
    s_waitcnt vmcnt(26)
    buffer_load_dwordx4 v12, s[24:27], s48 offen offset:0 nt lds
    buffer_load_dwordx4 v13, s[24:27], s48 offen offset:1024 nt lds
    buffer_load_dwordx4 v14, s[24:27], s48 offen offset:2048 nt lds
    buffer_load_dwordx4 v15, s[24:27], s48 offen offset:3072 nt lds
    s_add_u32 m0, s46, 8192
    s_add_u32 s48, s44, s34
    s_waitcnt vmcnt(26)
    buffer_load_dwordx4 v8, s[24:27], s48 offen offset:0 nt lds
    buffer_load_dwordx4 v9, s[24:27], s48 offen offset:1024 nt lds
    buffer_load_dwordx4 v10, s[24:27], s48 offen offset:2048 nt lds
    buffer_load_dwordx4 v11, s[24:27], s48 offen offset:3072 nt lds
    s_add_u32 m0, s46, 12288
    s_add_u32 s48, s44, s35
    s_waitcnt vmcnt(26)
    s_barrier
    buffer_load_dwordx4 v12, s[24:27], s48 offen offset:0 nt lds
    s_xor_b32 s44, s44, s39
    s_add_u32 s44, s44, 16384
    s_xor_b32 s44, s44, s39
    buffer_load_dwordx4 v13, s[24:27], s48 offen offset:1024 nt lds
    s_add_u32 s46, s46, 16384
    s_and_b32 s46, s46, 65535
    buffer_load_dwordx4 v14, s[24:27], s48 offen offset:2048 nt lds
    s_add_u32 s50, s50, 1
    buffer_load_dwordx4 v15, s[24:27], s48 offen offset:3072 nt lds
L_it19:
    s_add_u32 m0, s46, 0
    s_add_u32 s48, s44, s32
    s_waitcnt vmcnt(19)
    buffer_load_dwordx4 v8, s[24:27], s48 offen offset:0 nt lds
    s_waitcnt vmcnt(19)
    buffer_load_dwordx4 v9, s[24:27], s48 offen offset:1024 nt lds
    s_waitcnt vmcnt(19)
    buffer_load_dwordx4 v10, s[24:27], s48 offen offset:2048 nt lds
    s_waitcnt vmcnt(19)
    s_barrier
    buffer_load_dwordx4 v11, s[24:27], s48 offen offset:3072 nt lds
    s_add_u32 m0, s46, 4096
    s_add_u32 s48, s44, s33
    s_waitcnt vmcnt(19)
    buffer_load_dwordx4 v12, s[24:27], s48 offen offset:0 nt lds
    s_waitcnt vmcnt(19)
    buffer_load_dwordx4 v13, s[24:27], s48 offen offset:1024 nt lds
    s_waitcnt vmcnt(19)
    buffer_load_dwordx4 v14, s[24:27], s48 offen offset:2048 nt lds
    s_waitcnt vmcnt(19)
    buffer_load_dwordx4 v15, s[24:27], s48 offen offset:3072 nt lds
    s_add_u32 m0, s46, 8192
    s_add_u32 s48, s44, s34
    s_waitcnt vmcnt(19)
    s_memrealtime s[80:81]
    buffer_load_dwordx4 v8, s[24:27], s48 offen offset:0 nt lds
    s_waitcnt vmcnt(19)
    buffer_load_dwordx4 v9, s[24:27], s48 offen offset:1024 nt lds
    s_waitcnt lgkmcnt(0)
    s_lshl_b32 s47, s80, 4
    s_sub_i32 s47, s47, s52
    s_add_u32 s52, s52, s53
    s_waitcnt vmcnt(19)
    buffer_load_dwordx4 v10, s[24:27], s48 offen offset:2048 nt lds
    s_ashr_i32 s49, s47, 1
    s_max_i32 s47, s47, s49
    s_max_i32 s47, s47, -1280
    s_mul_i32 s47, s47, s54
    s_add_i32 s47, s47, s55
    s_ashr_i32 s47, s47, 13
    s_waitcnt vmcnt(19)
    buffer_load_dwordx4 v11, s[24:27], s48 offen offset:3072 nt lds
    s_add_u32 m0, s46, 12288
    s_add_u32 s48, s44, s35
    s_waitcnt vmcnt(19)
    buffer_load_dwordx4 v12, s[24:27], s48 offen offset:0 nt lds
    s_max_i32 s47, s47, 15
    s_min_i32 s93, s47, 31
    s_xor_b32 s44, s44, s39
    s_add_u32 s44, s44, 16384
    s_xor_b32 s44, s44, s39
    s_waitcnt vmcnt(19)
    buffer_load_dwordx4 v13, s[24:27], s48 offen offset:1024 nt lds
    s_cmp_gt_i32 s93, 23
    s_cselect_b32 s47, 3, 0
    s_or_b32 s93, s93, s47
    s_add_u32 s46, s46, 16384
    s_and_b32 s46, s46, 65535
    s_waitcnt vmcnt(19)
    buffer_load_dwordx4 v14, s[24:27], s48 offen offset:2048 nt lds
    s_add_u32 s50, s50, 1
    s_cmp_eq_u32 s50, s56
    s_waitcnt vmcnt(19)
    buffer_load_dwordx4 v15, s[24:27], s48 offen offset:3072 nt lds
    s_cbranch_scc1 L_event
    s_cmp_eq_u32 s93, 19
    s_cbranch_scc1 L_it19
    s_cmp_eq_u32 s93, 20
    s_cbranch_scc1 L_it20
    s_cmp_eq_u32 s93, 18
    s_cbranch_scc1 L_it18
L_disp:
    s_cmp_eq_u32 s93, 19
    s_cbranch_scc1 L_it19
    s_cmp_eq_u32 s93, 18
    s_cbranch_scc1 L_it18
    s_cmp_eq_u32 s93, 20
    s_cbranch_scc1 L_it20
    s_cmp_eq_u32 s93, 17
    s_cbranch_scc1 L_it17
    s_cmp_eq_u32 s93, 21
    s_cbranch_scc1 L_it21
    s_cmp_eq_u32 s93, 16
    s_cbranch_scc1 L_it16
    s_cmp_eq_u32 s93, 22
    s_cbranch_scc1 L_it22
    s_cmp_eq_u32 s93, 15
    s_cbranch_scc1 L_it15
    s_cmp_eq_u32 s93, 23
    s_cbranch_scc1 L_it23
    s_cmp_eq_u32 s93, 27
    s_cbranch_scc1 L_it27
    s_branch L_it31
L_event:
    s_cmp_lg_u32 s50, s51
    s_cbranch_scc1 L_ctl
    s_cmp_eq_u32 s50, 128
    s_cbranch_scc1 L_drain
    v_xor_b32 v8, v8, v32
    v_xor_b32 v9, v9, v33
    v_xor_b32 v10, v10, v34
    v_xor_b32 v11, v11, v35
    v_xor_b32 v12, v12, v36
    v_xor_b32 v13, v13, v37
    v_xor_b32 v14, v14, v38
    v_xor_b32 v15, v15, v39
    s_mov_b64 s[30:31], s[24:25]
    s_mov_b64 s[24:25], s[28:29]
    s_mov_b64 s[28:29], s[30:31]
    s_mov_b32 s47, s44
    s_mov_b32 s44, s45
    s_mov_b32 s45, s47
    s_cmp_ge_u32 s50, 88
    s_cselect_b32 s47, 20, 22
    s_add_u32 s51, s51, s47
    s_min_u32 s56, s51, s57
    s_cmp_lg_u32 s50, s57
    s_cbranch_scc1 L_disp
L_ctl:
    s_xor_b32 s85, s85, 1
    s_cbranch_scc0 L_cmp
    s_mov_b64 exec, 0xffff
    global_load_dword v29, v28, s[22:23] sc1
    s_mov_b64 exec, -1
    s_add_u32 s57, s57, s58
    s_min_u32 s56, s51, s57
    s_mov_b32 s82, s90
    s_mov_b32 s90, s80
    v_add_u32 v28, 4352, v28
    s_cmp_lg_u32 s87, 5
    s_cbranch_scc1 L_disp
    v_add_u32 v27, 4352, v27
    v_mov_b32 v30, s90
    s_mov_b32 exec_hi, 0
    global_store_dword v27, v30, s[22:23] sc1
    s_mov_b32 exec_hi, -1
    s_branch L_disp
L_cmp:
    s_add_u32 s57, s57, s59
    s_min_u32 s56, s51, s57
    s_sub_u32 s83, s90, s78
    v_subrev_u32 v29, s78, v29
    v_min_u32 v29, s83, v29
    s_sub_u32 s47, s82, s78
    s_lshl_b32 s47, s47, 4
    v_add_u32_dpp v29, v29, v29 row_ror:1 row_mask:0xf bank_mask:0xf
    s_lshl_b32 s91, s78, 4
    s_lshr_b32 s31, s89, 3
    v_add_u32_dpp v29, v29, v29 row_ror:2 row_mask:0xf bank_mask:0xf
    s_add_u32 s31, s31, s89
    s_mov_b32 s86, s88
    v_add_u32_dpp v29, v29, v29 row_ror:4 row_mask:0xf bank_mask:0xf
    s_nop 1
    v_add_u32_dpp v29, v29, v29 row_ror:8 row_mask:0xf bank_mask:0xf
    s_nop 0
    v_readfirstlane_b32 s88, v29
    s_nop 0
    s_sub_i32 s47, s47, s88
    s_cmp_lg_u32 s54, 0
    s_cbranch_scc1 L_step
    s_mov_b32 s53, 868
    s_lshl_b32 s52, s80, 4
    s_sub_u32 s52, s52, s47
    s_add_u32 s52, s52, s53
    s_mov_b32 s88, 0
    s_lshr_b32 s58, s2, 4
    s_and_b32 s58, s58, 3
    s_add_u32 s58, s58, 2
    s_sub_u32 s59, 8, s58
    s_add_u32 s92, s58, 9
    s_mov_b32 s54, 64
    s_branch L_disp
L_step:
    s_sub_u32 s49, s88, s86
    s_min_u32 s49, s49, s31
    s_cmp_eq_u32 s86, 0
    s_cselect_b32 s49, s89, s49
    s_cselect_b32 s47, 0, s47
    s_add_i32 s84, s84, s47
    s_sub_i32 s49, s49, s89
    s_ashr_i32 s49, s49, 2
    s_add_i32 s89, s89, s49
    s_mul_i32 s53, s89, 512
    s_lshr_b32 s53, s53, 12
    s_mul_i32 s52, s53, s92
    s_add_u32 s52, s52, s88
    s_add_u32 s52, s52, s91
    s_max_i32 s84, s84, -24576
    s_min_i32 s84, s84, 24576
    s_mul_i32 s55, s84, 1
    s_add_i32 s55, s55, s94
    s_branch L_disp
L_it18:
    s_add_u32 m0, s46, 0
    s_add_u32 s48, s44, s32
    s_waitcnt vmcnt(18)
    buffer_load_dwordx4 v8, s[24:27], s48 offen offset:0 nt lds
    s_waitcnt vmcnt(18)
    buffer_load_dwordx4 v9, s[24:27], s48 offen offset:1024 nt lds
    s_waitcnt vmcnt(18)
    s_barrier
    buffer_load_dwordx4 v10, s[24:27], s48 offen offset:2048 nt lds
    s_waitcnt vmcnt(18)
    buffer_load_dwordx4 v11, s[24:27], s48 offen offset:3072 nt lds
    s_add_u32 m0, s46, 4096
    s_add_u32 s48, s44, s33
    s_waitcnt vmcnt(18)
    buffer_load_dwordx4 v12, s[24:27], s48 offen offset:0 nt lds
    s_waitcnt vmcnt(18)
    buffer_load_dwordx4 v13, s[24:27], s48 offen offset:1024 nt lds
    s_waitcnt vmcnt(18)
    buffer_load_dwordx4 v14, s[24:27], s48 offen offset:2048 nt lds
    s_waitcnt vmcnt(18)
    buffer_load_dwordx4 v15, s[24:27], s48 offen offset:3072 nt lds
    s_add_u32 m0, s46, 8192
    s_add_u32 s48, s44, s34
    s_waitcnt vmcnt(18)
    s_memrealtime s[80:81]
    buffer_load_dwordx4 v8, s[24:27], s48 offen offset:0 nt lds
    s_waitcnt vmcnt(18)
    buffer_load_dwordx4 v9, s[24:27], s48 offen offset:1024 nt lds
    s_waitcnt lgkmcnt(0)
    s_add_u32 s80, s80, 0xfffffffd
    s_lshl_b32 s47, s80, 4
    s_sub_i32 s47, s47, s52
    s_add_u32 s52, s52, s53
    s_waitcnt vmcnt(18)
    buffer_load_dwordx4 v10, s[24:27], s48 offen offset:2048 nt lds
    s_ashr_i32 s49, s47, 1
    s_max_i32 s47, s47, s49
    s_max_i32 s47, s47, -1280
    s_mul_i32 s47, s47, s54
    s_add_i32 s47, s47, s55
    s_ashr_i32 s47, s47, 13
    s_waitcnt vmcnt(18)
    buffer_load_dwordx4 v11, s[24:27], s48 offen offset:3072 nt lds
    s_add_u32 m0, s46, 12288
    s_add_u32 s48, s44, s35
    s_waitcnt vmcnt(18)
    buffer_load_dwordx4 v12, s[24:27], s48 offen offset:0 nt lds
    s_max_i32 s47, s47, 15
    s_min_i32 s93, s47, 31
    s_xor_b32 s44, s44, s39
    s_add_u32 s44, s44, 16384
    s_xor_b32 s44, s44, s39
    s_waitcnt vmcnt(18)
    buffer_load_dwordx4 v13, s[24:27], s48 offen offset:1024 nt lds
    s_cmp_gt_i32 s93, 23
    s_cselect_b32 s47, 3, 0
    s_or_b32 s93, s93, s47
    s_add_u32 s46, s46, 16384
    s_and_b32 s46, s46, 65535
    s_waitcnt vmcnt(18)
    buffer_load_dwordx4 v14, s[24:27], s48 offen offset:2048 nt lds
    s_add_u32 s50, s50, 1
    s_cmp_eq_u32 s50, s56
    s_waitcnt vmcnt(18)
    buffer_load_dwordx4 v15, s[24:27], s48 offen offset:3072 nt lds
    s_cbranch_scc1 L_event
    s_cmp_eq_u32 s93, 18
    s_cbranch_scc1 L_it18
    s_cmp_eq_u32 s93, 19
    s_cbranch_scc1 L_it19
    s_cmp_eq_u32 s93, 17
    s_cbranch_scc1 L_it17
    s_branch L_disp
L_it20:
    s_add_u32 m0, s46, 0
    s_add_u32 s48, s44, s32
    s_waitcnt vmcnt(20)
    buffer_load_dwordx4 v8, s[24:27], s48 offen offset:0 nt lds
    s_waitcnt vmcnt(20)
    buffer_load_dwordx4 v9, s[24:27], s48 offen offset:1024 nt lds
    s_waitcnt vmcnt(20)
    buffer_load_dwordx4 v10, s[24:27], s48 offen offset:2048 nt lds
    s_waitcnt vmcnt(20)
    buffer_load_dwordx4 v11, s[24:27], s48 offen offset:3072 nt lds
    s_add_u32 m0, s46, 4096
    s_add_u32 s48, s44, s33
    s_waitcnt vmcnt(20)
    s_barrier
    buffer_load_dwordx4 v12, s[24:27], s48 offen offset:0 nt lds
    s_waitcnt vmcnt(20)
    buffer_load_dwordx4 v13, s[24:27], s48 offen offset:1024 nt lds
    s_waitcnt vmcnt(20)
    buffer_load_dwordx4 v14, s[24:27], s48 offen offset:2048 nt lds
    s_waitcnt vmcnt(20)
    buffer_load_dwordx4 v15, s[24:27], s48 offen offset:3072 nt lds
    s_add_u32 m0, s46, 8192
    s_add_u32 s48, s44, s34
    s_waitcnt vmcnt(20)
    s_memrealtime s[80:81]
    buffer_load_dwordx4 v8, s[24:27], s48 offen offset:0 nt lds
    s_waitcnt vmcnt(20)
    buffer_load_dwordx4 v9, s[24:27], s48 offen offset:1024 nt lds
    s_waitcnt lgkmcnt(0)
    s_add_u32 s80, s80, 0x3
    s_lshl_b32 s47, s80, 4
    s_sub_i32 s47, s47, s52
    s_add_u32 s52, s52, s53
    s_waitcnt vmcnt(20)
    buffer_load_dwordx4 v10, s[24:27], s48 offen offset:2048 nt lds
    s_ashr_i32 s49, s47, 1
    s_max_i32 s47, s47, s49
    s_max_i32 s47, s47, -1280
    s_mul_i32 s47, s47, s54
    s_add_i32 s47, s47, s55
    s_ashr_i32 s47, s47, 13
    s_waitcnt vmcnt(20)
    buffer_load_dwordx4 v11, s[24:27], s48 offen offset:3072 nt lds
    s_add_u32 m0, s46, 12288
    s_add_u32 s48, s44, s35
    s_waitcnt vmcnt(20)
    buffer_load_dwordx4 v12, s[24:27], s48 offen offset:0 nt lds
    s_max_i32 s47, s47, 15
    s_min_i32 s93, s47, 31
    s_xor_b32 s44, s44, s39
    s_add_u32 s44, s44, 16384
    s_xor_b32 s44, s44, s39
    s_waitcnt vmcnt(20)
    buffer_load_dwordx4 v13, s[24:27], s48 offen offset:1024 nt lds
    s_cmp_gt_i32 s93, 23
    s_cselect_b32 s47, 3, 0
    s_or_b32 s93, s93, s47
    s_add_u32 s46, s46, 16384
    s_and_b32 s46, s46, 65535
    s_waitcnt vmcnt(20)
    buffer_load_dwordx4 v14, s[24:27], s48 offen offset:2048 nt lds
    s_add_u32 s50, s50, 1
    s_cmp_eq_u32 s50, s56
    s_waitcnt vmcnt(20)
    buffer_load_dwordx4 v15, s[24:27], s48 offen offset:3072 nt lds
    s_cbranch_scc1 L_event
    s_cmp_eq_u32 s93, 20
    s_cbranch_scc1 L_it20
    s_cmp_eq_u32 s93, 21
    s_cbranch_scc1 L_it21
    s_cmp_eq_u32 s93, 19
    s_cbranch_scc1 L_it19
    s_branch L_disp
L_it17:
    s_add_u32 m0, s46, 0
    s_add_u32 s48, s44, s32
    s_waitcnt vmcnt(17)
    buffer_load_dwordx4 v8, s[24:27], s48 offen offset:0 nt lds
    s_waitcnt vmcnt(17)
    s_barrier
    buffer_load_dwordx4 v9, s[24:27], s48 offen offset:1024 nt lds
    s_waitcnt vmcnt(17)
    buffer_load_dwordx4 v10, s[24:27], s48 offen offset:2048 nt lds
    s_waitcnt vmcnt(17)
    buffer_load_dwordx4 v11, s[24:27], s48 offen offset:3072 nt lds
    s_add_u32 m0, s46, 4096
    s_add_u32 s48, s44, s33
    s_waitcnt vmcnt(17)
    buffer_load_dwordx4 v12, s[24:27], s48 offen offset:0 nt lds
    s_waitcnt vmcnt(17)
    buffer_load_dwordx4 v13, s[24:27], s48 offen offset:1024 nt lds
    s_waitcnt vmcnt(17)
    buffer_load_dwordx4 v14, s[24:27], s48 offen offset:2048 nt lds
    s_waitcnt vmcnt(17)
    buffer_load_dwordx4 v15, s[24:27], s48 offen offset:3072 nt lds
    s_add_u32 m0, s46, 8192
    s_add_u32 s48, s44, s34
    s_waitcnt vmcnt(17)
    s_memrealtime s[80:81]
    buffer_load_dwordx4 v8, s[24:27], s48 offen offset:0 nt lds
    s_waitcnt vmcnt(17)
    buffer_load_dwordx4 v9, s[24:27], s48 offen offset:1024 nt lds
    s_waitcnt lgkmcnt(0)
    s_add_u32 s80, s80, 0xfffffff9
    s_lshl_b32 s47, s80, 4
    s_sub_i32 s47, s47, s52
    s_add_u32 s52, s52, s53
    s_waitcnt vmcnt(17)
    buffer_load_dwordx4 v10, s[24:27], s48 offen offset:2048 nt lds
    s_ashr_i32 s49, s47, 1
    s_max_i32 s47, s47, s49
    s_max_i32 s47, s47, -1280
    s_mul_i32 s47, s47, s54
    s_add_i32 s47, s47, s55
    s_ashr_i32 s47, s47, 13
    s_waitcnt vmcnt(17)
    buffer_load_dwordx4 v11, s[24:27], s48 offen offset:3072 nt lds
    s_add_u32 m0, s46, 12288
    s_add_u32 s48, s44, s35
    s_waitcnt vmcnt(17)
    buffer_load_dwordx4 v12, s[24:27], s48 offen offset:0 nt lds
    s_max_i32 s47, s47, 15
    s_min_i32 s93, s47, 31
    s_xor_b32 s44, s44, s39
    s_add_u32 s44, s44, 16384
    s_xor_b32 s44, s44, s39
    s_waitcnt vmcnt(17)
    buffer_load_dwordx4 v13, s[24:27], s48 offen offset:1024 nt lds
    s_cmp_gt_i32 s93, 23
    s_cselect_b32 s47, 3, 0
    s_or_b32 s93, s93, s47
    s_add_u32 s46, s46, 16384
    s_and_b32 s46, s46, 65535
    s_waitcnt vmcnt(17)
    buffer_load_dwordx4 v14, s[24:27], s48 offen offset:2048 nt lds
    s_add_u32 s50, s50, 1
    s_cmp_eq_u32 s50, s56
    s_waitcnt vmcnt(17)
    buffer_load_dwordx4 v15, s[24:27], s48 offen offset:3072 nt lds
    s_cbranch_scc1 L_event
    s_cmp_eq_u32 s93, 17
    s_cbranch_scc1 L_it17
    s_cmp_eq_u32 s93, 18
    s_cbranch_scc1 L_it18
    s_cmp_eq_u32 s93, 16
    s_cbranch_scc1 L_it16
    s_branch L_disp
L_it21:
    s_add_u32 m0, s46, 0
    s_add_u32 s48, s44, s32
    s_waitcnt vmcnt(21)
    buffer_load_dwordx4 v8, s[24:27], s48 offen offset:0 nt lds
    s_waitcnt vmcnt(21)
    buffer_load_dwordx4 v9, s[24:27], s48 offen offset:1024 nt lds
    s_waitcnt vmcnt(21)
    buffer_load_dwordx4 v10, s[24:27], s48 offen offset:2048 nt lds
    s_waitcnt vmcnt(21)
    buffer_load_dwordx4 v11, s[24:27], s48 offen offset:3072 nt lds
    s_add_u32 m0, s46, 4096
    s_add_u32 s48, s44, s33
    s_waitcnt vmcnt(21)
    buffer_load_dwordx4 v12, s[24:27], s48 offen offset:0 nt lds
    s_waitcnt vmcnt(21)
    s_barrier
    buffer_load_dwordx4 v13, s[24:27], s48 offen offset:1024 nt lds
    s_waitcnt vmcnt(21)
    buffer_load_dwordx4 v14, s[24:27], s48 offen offset:2048 nt lds
    s_waitcnt vmcnt(21)
    buffer_load_dwordx4 v15, s[24:27], s48 offen offset:3072 nt lds
    s_add_u32 m0, s46, 8192
    s_add_u32 s48, s44, s34
    s_waitcnt vmcnt(21)
    s_memrealtime s[80:81]
    buffer_load_dwordx4 v8, s[24:27], s48 offen offset:0 nt lds
    s_waitcnt vmcnt(21)
    buffer_load_dwordx4 v9, s[24:27], s48 offen offset:1024 nt lds
    s_waitcnt lgkmcnt(0)
    s_add_u32 s80, s80, 0x7
    s_lshl_b32 s47, s80, 4
    s_sub_i32 s47, s47, s52
    s_add_u32 s52, s52, s53
    s_waitcnt vmcnt(21)
    buffer_load_dwordx4 v10, s[24:27], s48 offen offset:2048 nt lds
    s_ashr_i32 s49, s47, 1
    s_max_i32 s47, s47, s49
    s_max_i32 s47, s47, -1280
    s_mul_i32 s47, s47, s54
    s_add_i32 s47, s47, s55
    s_ashr_i32 s47, s47, 13
    s_waitcnt vmcnt(21)
    buffer_load_dwordx4 v11, s[24:27], s48 offen offset:3072 nt lds
    s_add_u32 m0, s46, 12288
    s_add_u32 s48, s44, s35
    s_waitcnt vmcnt(21)
    buffer_load_dwordx4 v12, s[24:27], s48 offen offset:0 nt lds
    s_max_i32 s47, s47, 15
    s_min_i32 s93, s47, 31
    s_xor_b32 s44, s44, s39
    s_add_u32 s44, s44, 16384
    s_xor_b32 s44, s44, s39
    s_waitcnt vmcnt(21)
    buffer_load_dwordx4 v13, s[24:27], s48 offen offset:1024 nt lds
    s_cmp_gt_i32 s93, 23
    s_cselect_b32 s47, 3, 0
    s_or_b32 s93, s93, s47
    s_add_u32 s46, s46, 16384
    s_and_b32 s46, s46, 65535
    s_waitcnt vmcnt(21)
    buffer_load_dwordx4 v14, s[24:27], s48 offen offset:2048 nt lds
    s_add_u32 s50, s50, 1
    s_cmp_eq_u32 s50, s56
    s_waitcnt vmcnt(21)
    buffer_load_dwordx4 v15, s[24:27], s48 offen offset:3072 nt lds
    s_cbranch_scc1 L_event
    s_cmp_eq_u32 s93, 21
    s_cbranch_scc1 L_it21
    s_cmp_eq_u32 s93, 22
    s_cbranch_scc1 L_it22
    s_cmp_eq_u32 s93, 20
    s_cbranch_scc1 L_it20
    s_branch L_disp
L_it16:
    s_add_u32 m0, s46, 0
    s_add_u32 s48, s44, s32
    s_waitcnt vmcnt(16)
    s_barrier
    buffer_load_dwordx4 v8, s[24:27], s48 offen offset:0 nt lds
    s_waitcnt vmcnt(16)
    buffer_load_dwordx4 v9, s[24:27], s48 offen offset:1024 nt lds
    s_waitcnt vmcnt(16)
    buffer_load_dwordx4 v10, s[24:27], s48 offen offset:2048 nt lds
    s_waitcnt vmcnt(16)
    buffer_load_dwordx4 v11, s[24:27], s48 offen offset:3072 nt lds
    s_add_u32 m0, s46, 4096
    s_add_u32 s48, s44, s33
    s_waitcnt vmcnt(16)
    buffer_load_dwordx4 v12, s[24:27], s48 offen offset:0 nt lds
    s_waitcnt vmcnt(16)
    buffer_load_dwordx4 v13, s[24:27], s48 offen offset:1024 nt lds
    s_waitcnt vmcnt(16)
    buffer_load_dwordx4 v14, s[24:27], s48 offen offset:2048 nt lds
    s_waitcnt vmcnt(16)
    buffer_load_dwordx4 v15, s[24:27], s48 offen offset:3072 nt lds
    s_add_u32 m0, s46, 8192
    s_add_u32 s48, s44, s34
    s_waitcnt vmcnt(16)
    s_memrealtime s[80:81]
    buffer_load_dwordx4 v8, s[24:27], s48 offen offset:0 nt lds
    s_waitcnt vmcnt(16)
    buffer_load_dwordx4 v9, s[24:27], s48 offen offset:1024 nt lds
    s_waitcnt lgkmcnt(0)
    s_add_u32 s80, s80, 0xfffffff6
    s_lshl_b32 s47, s80, 4
    s_sub_i32 s47, s47, s52
    s_add_u32 s52, s52, s53
    s_waitcnt vmcnt(16)
    buffer_load_dwordx4 v10, s[24:27], s48 offen offset:2048 nt lds
    s_ashr_i32 s49, s47, 1
    s_max_i32 s47, s47, s49
    s_max_i32 s47, s47, -1280
    s_mul_i32 s47, s47, s54
    s_add_i32 s47, s47, s55
    s_ashr_i32 s47, s47, 13
    s_waitcnt vmcnt(16)
    buffer_load_dwordx4 v11, s[24:27], s48 offen offset:3072 nt lds
    s_add_u32 m0, s46, 12288
    s_add_u32 s48, s44, s35
    s_waitcnt vmcnt(16)
    buffer_load_dwordx4 v12, s[24:27], s48 offen offset:0 nt lds
    s_max_i32 s47, s47, 15
    s_min_i32 s93, s47, 31
    s_xor_b32 s44, s44, s39
    s_add_u32 s44, s44, 16384
    s_xor_b32 s44, s44, s39
    s_waitcnt vmcnt(16)
    buffer_load_dwordx4 v13, s[24:27], s48 offen offset:1024 nt lds
    s_cmp_gt_i32 s93, 23
    s_cselect_b32 s47, 3, 0
    s_or_b32 s93, s93, s47
    s_add_u32 s46, s46, 16384
    s_and_b32 s46, s46, 65535
    s_waitcnt vmcnt(16)
    buffer_load_dwordx4 v14, s[24:27], s48 offen offset:2048 nt lds
    s_add_u32 s50, s50, 1
    s_cmp_eq_u32 s50, s56
    s_waitcnt vmcnt(16)
    buffer_load_dwordx4 v15, s[24:27], s48 offen offset:3072 nt lds
    s_cbranch_scc1 L_event
    s_cmp_eq_u32 s93, 16
    s_cbranch_scc1 L_it16
    s_cmp_eq_u32 s93, 17
    s_cbranch_scc1 L_it17
    s_cmp_eq_u32 s93, 15
    s_cbranch_scc1 L_it15
    s_branch L_disp
L_it22:
    s_add_u32 m0, s46, 0
    s_add_u32 s48, s44, s32
    s_waitcnt vmcnt(22)
    buffer_load_dwordx4 v8, s[24:27], s48 offen offset:0 nt lds
    s_waitcnt vmcnt(22)
    buffer_load_dwordx4 v9, s[24:27], s48 offen offset:1024 nt lds
    s_waitcnt vmcnt(22)
    buffer_load_dwordx4 v10, s[24:27], s48 offen offset:2048 nt lds
    s_waitcnt vmcnt(22)
    buffer_load_dwordx4 v11, s[24:27], s48 offen offset:3072 nt lds
    s_add_u32 m0, s46, 4096
    s_add_u32 s48, s44, s33
    s_waitcnt vmcnt(22)
    buffer_load_dwordx4 v12, s[24:27], s48 offen offset:0 nt lds
    s_waitcnt vmcnt(22)
    buffer_load_dwordx4 v13, s[24:27], s48 offen offset:1024 nt lds
    s_waitcnt vmcnt(22)
    s_barrier
    buffer_load_dwordx4 v14, s[24:27], s48 offen offset:2048 nt lds
    s_waitcnt vmcnt(22)
    buffer_load_dwordx4 v15, s[24:27], s48 offen offset:3072 nt lds
    s_add_u32 m0, s46, 8192
    s_add_u32 s48, s44, s34
    s_waitcnt vmcnt(22)
    s_memrealtime s[80:81]
    buffer_load_dwordx4 v8, s[24:27], s48 offen offset:0 nt lds
    s_waitcnt vmcnt(22)
    buffer_load_dwordx4 v9, s[24:27], s48 offen offset:1024 nt lds
    s_waitcnt lgkmcnt(0)
    s_add_u32 s80, s80, 0xa
    s_lshl_b32 s47, s80, 4
    s_sub_i32 s47, s47, s52
    s_add_u32 s52, s52, s53
    s_waitcnt vmcnt(22)
    buffer_load_dwordx4 v10, s[24:27], s48 offen offset:2048 nt lds
    s_ashr_i32 s49, s47, 1
    s_max_i32 s47, s47, s49
    s_max_i32 s47, s47, -1280
    s_mul_i32 s47, s47, s54
    s_add_i32 s47, s47, s55
    s_ashr_i32 s47, s47, 13
    s_waitcnt vmcnt(22)
    buffer_load_dwordx4 v11, s[24:27], s48 offen offset:3072 nt lds
    s_add_u32 m0, s46, 12288
    s_add_u32 s48, s44, s35
    s_waitcnt vmcnt(22)
    buffer_load_dwordx4 v12, s[24:27], s48 offen offset:0 nt lds
    s_max_i32 s47, s47, 15
    s_min_i32 s93, s47, 31
    s_xor_b32 s44, s44, s39
    s_add_u32 s44, s44, 16384
    s_xor_b32 s44, s44, s39
    s_waitcnt vmcnt(22)
    buffer_load_dwordx4 v13, s[24:27], s48 offen offset:1024 nt lds
    s_cmp_gt_i32 s93, 23
    s_cselect_b32 s47, 3, 0
    s_or_b32 s93, s93, s47
    s_add_u32 s46, s46, 16384
    s_and_b32 s46, s46, 65535
    s_waitcnt vmcnt(22)
    buffer_load_dwordx4 v14, s[24:27], s48 offen offset:2048 nt lds
    s_add_u32 s50, s50, 1
    s_cmp_eq_u32 s50, s56
    s_waitcnt vmcnt(22)
    buffer_load_dwordx4 v15, s[24:27], s48 offen offset:3072 nt lds
    s_cbranch_scc1 L_event
    s_cmp_eq_u32 s93, 22
    s_cbranch_scc1 L_it22
    s_cmp_eq_u32 s93, 23
    s_cbranch_scc1 L_it23
    s_cmp_eq_u32 s93, 21
    s_cbranch_scc1 L_it21
    s_branch L_disp
L_it15:
    s_add_u32 m0, s46, 0
    s_add_u32 s48, s44, s32
    s_waitcnt vmcnt(15)
    s_barrier
    buffer_load_dwordx4 v8, s[24:27], s48 offen offset:0 nt lds
    s_waitcnt vmcnt(15)
    buffer_load_dwordx4 v9, s[24:27], s48 offen offset:1024 nt lds
    s_waitcnt vmcnt(15)
    buffer_load_dwordx4 v10, s[24:27], s48 offen offset:2048 nt lds
    s_waitcnt vmcnt(15)
    buffer_load_dwordx4 v11, s[24:27], s48 offen offset:3072 nt lds
    s_add_u32 m0, s46, 4096
    s_add_u32 s48, s44, s33
    s_waitcnt vmcnt(15)
    buffer_load_dwordx4 v12, s[24:27], s48 offen offset:0 nt lds
    s_waitcnt vmcnt(15)
    buffer_load_dwordx4 v13, s[24:27], s48 offen offset:1024 nt lds
    s_waitcnt vmcnt(15)
    buffer_load_dwordx4 v14, s[24:27], s48 offen offset:2048 nt lds
    s_waitcnt vmcnt(15)
    buffer_load_dwordx4 v15, s[24:27], s48 offen offset:3072 nt lds
    s_add_u32 m0, s46, 8192
    s_add_u32 s48, s44, s34
    s_waitcnt vmcnt(15)
    s_memrealtime s[80:81]
    buffer_load_dwordx4 v8, s[24:27], s48 offen offset:0 nt lds
    s_waitcnt vmcnt(15)
    buffer_load_dwordx4 v9, s[24:27], s48 offen offset:1024 nt lds
    s_waitcnt lgkmcnt(0)
    s_add_u32 s80, s80, 0xfffffff2
    s_lshl_b32 s47, s80, 4
    s_sub_i32 s47, s47, s52
    s_add_u32 s52, s52, s53
    s_waitcnt vmcnt(15)
    buffer_load_dwordx4 v10, s[24:27], s48 offen offset:2048 nt lds
    s_ashr_i32 s49, s47, 1
    s_max_i32 s47, s47, s49
    s_max_i32 s47, s47, -1280
    s_mul_i32 s47, s47, s54
    s_add_i32 s47, s47, s55
    s_ashr_i32 s47, s47, 13
    s_waitcnt vmcnt(15)
    buffer_load_dwordx4 v11, s[24:27], s48 offen offset:3072 nt lds
    s_add_u32 m0, s46, 12288
    s_add_u32 s48, s44, s35
    s_waitcnt vmcnt(15)
    buffer_load_dwordx4 v12, s[24:27], s48 offen offset:0 nt lds
    s_max_i32 s47, s47, 15
    s_min_i32 s93, s47, 31
    s_xor_b32 s44, s44, s39
    s_add_u32 s44, s44, 16384
    s_xor_b32 s44, s44, s39
    s_waitcnt vmcnt(15)
    buffer_load_dwordx4 v13, s[24:27], s48 offen offset:1024 nt lds
    s_cmp_gt_i32 s93, 23
    s_cselect_b32 s47, 3, 0
    s_or_b32 s93, s93, s47
    s_add_u32 s46, s46, 16384
    s_and_b32 s46, s46, 65535
    s_waitcnt vmcnt(15)
    buffer_load_dwordx4 v14, s[24:27], s48 offen offset:2048 nt lds
    s_add_u32 s50, s50, 1
    s_cmp_eq_u32 s50, s56
    s_waitcnt vmcnt(15)
    buffer_load_dwordx4 v15, s[24:27], s48 offen offset:3072 nt lds
    s_cbranch_scc1 L_event
    s_cmp_eq_u32 s93, 15
    s_cbranch_scc1 L_it15
    s_cmp_eq_u32 s93, 16
    s_cbranch_scc1 L_it16
    s_branch L_disp
L_it23:
    s_add_u32 m0, s46, 0
    s_add_u32 s48, s44, s32
    s_waitcnt vmcnt(23)
    buffer_load_dwordx4 v8, s[24:27], s48 offen offset:0 nt lds
    s_waitcnt vmcnt(23)
    buffer_load_dwordx4 v9, s[24:27], s48 offen offset:1024 nt lds
    s_waitcnt vmcnt(23)
    buffer_load_dwordx4 v10, s[24:27], s48 offen offset:2048 nt lds
    s_waitcnt vmcnt(23)
    buffer_load_dwordx4 v11, s[24:27], s48 offen offset:3072 nt lds
    s_add_u32 m0, s46, 4096
    s_add_u32 s48, s44, s33
    s_waitcnt vmcnt(23)
    buffer_load_dwordx4 v12, s[24:27], s48 offen offset:0 nt lds
    s_waitcnt vmcnt(23)
    buffer_load_dwordx4 v13, s[24:27], s48 offen offset:1024 nt lds
    s_waitcnt vmcnt(23)
    buffer_load_dwordx4 v14, s[24:27], s48 offen offset:2048 nt lds
    s_waitcnt vmcnt(23)
    s_barrier
    buffer_load_dwordx4 v15, s[24:27], s48 offen offset:3072 nt lds
    s_add_u32 m0, s46, 8192
    s_add_u32 s48, s44, s34
    s_waitcnt vmcnt(23)
    s_memrealtime s[80:81]
    buffer_load_dwordx4 v8, s[24:27], s48 offen offset:0 nt lds
    s_waitcnt vmcnt(23)
    buffer_load_dwordx4 v9, s[24:27], s48 offen offset:1024 nt lds
    s_waitcnt lgkmcnt(0)
    s_add_u32 s80, s80, 0xe
    s_lshl_b32 s47, s80, 4
    s_sub_i32 s47, s47, s52
    s_add_u32 s52, s52, s53
    s_waitcnt vmcnt(23)
    buffer_load_dwordx4 v10, s[24:27], s48 offen offset:2048 nt lds
    s_ashr_i32 s49, s47, 1
    s_max_i32 s47, s47, s49
    s_max_i32 s47, s47, -1280
    s_mul_i32 s47, s47, s54
    s_add_i32 s47, s47, s55
    s_ashr_i32 s47, s47, 13
    s_waitcnt vmcnt(23)
    buffer_load_dwordx4 v11, s[24:27], s48 offen offset:3072 nt lds
    s_add_u32 m0, s46, 12288
    s_add_u32 s48, s44, s35
    s_waitcnt vmcnt(23)
    buffer_load_dwordx4 v12, s[24:27], s48 offen offset:0 nt lds
    s_max_i32 s47, s47, 15
    s_min_i32 s93, s47, 31
    s_xor_b32 s44, s44, s39
    s_add_u32 s44, s44, 16384
    s_xor_b32 s44, s44, s39
    s_waitcnt vmcnt(23)
    buffer_load_dwordx4 v13, s[24:27], s48 offen offset:1024 nt lds
    s_cmp_gt_i32 s93, 23
    s_cselect_b32 s47, 3, 0
    s_or_b32 s93, s93, s47
    s_add_u32 s46, s46, 16384
    s_and_b32 s46, s46, 65535
    s_waitcnt vmcnt(23)
    buffer_load_dwordx4 v14, s[24:27], s48 offen offset:2048 nt lds
    s_add_u32 s50, s50, 1
    s_cmp_eq_u32 s50, s56
    s_waitcnt vmcnt(23)
    buffer_load_dwordx4 v15, s[24:27], s48 offen offset:3072 nt lds
    s_cbranch_scc1 L_event
    s_cmp_eq_u32 s93, 23
    s_cbranch_scc1 L_it23
    s_cmp_eq_u32 s93, 27
    s_cbranch_scc1 L_it27
    s_cmp_eq_u32 s93, 22
    s_cbranch_scc1 L_it22
    s_branch L_disp
L_it27:
    s_add_u32 m0, s46, 0
    s_add_u32 s48, s44, s32
    s_waitcnt vmcnt(27)
    buffer_load_dwordx4 v8, s[24:27], s48 offen offset:0 nt lds
    s_waitcnt vmcnt(27)
    buffer_load_dwordx4 v9, s[24:27], s48 offen offset:1024 nt lds
    s_waitcnt vmcnt(27)
    buffer_load_dwordx4 v10, s[24:27], s48 offen offset:2048 nt lds
    s_waitcnt vmcnt(27)
    buffer_load_dwordx4 v11, s[24:27], s48 offen offset:3072 nt lds
    s_add_u32 m0, s46, 4096
    s_add_u32 s48, s44, s33
    s_waitcnt vmcnt(27)
    buffer_load_dwordx4 v12, s[24:27], s48 offen offset:0 nt lds
    s_waitcnt vmcnt(27)
    buffer_load_dwordx4 v13, s[24:27], s48 offen offset:1024 nt lds
    s_waitcnt vmcnt(27)
    buffer_load_dwordx4 v14, s[24:27], s48 offen offset:2048 nt lds
    s_waitcnt vmcnt(27)
    buffer_load_dwordx4 v15, s[24:27], s48 offen offset:3072 nt lds
    s_add_u32 m0, s46, 8192
    s_add_u32 s48, s44, s34
    s_waitcnt vmcnt(27)
    s_memrealtime s[80:81]
    buffer_load_dwordx4 v8, s[24:27], s48 offen offset:0 nt lds
    s_waitcnt vmcnt(27)
    buffer_load_dwordx4 v9, s[24:27], s48 offen offset:1024 nt lds
    s_waitcnt lgkmcnt(0)
    s_add_u32 s80, s80, 0x1b
    s_lshl_b32 s47, s80, 4
    s_sub_i32 s47, s47, s52
    s_add_u32 s52, s52, s53
    s_waitcnt vmcnt(27)
    buffer_load_dwordx4 v10, s[24:27], s48 offen offset:2048 nt lds
    s_ashr_i32 s49, s47, 1
    s_max_i32 s47, s47, s49
    s_max_i32 s47, s47, -1280
    s_mul_i32 s47, s47, s54
    s_add_i32 s47, s47, s55
    s_ashr_i32 s47, s47, 13
    s_waitcnt vmcnt(27)
    s_barrier
    buffer_load_dwordx4 v11, s[24:27], s48 offen offset:3072 nt lds
    s_add_u32 m0, s46, 12288
    s_add_u32 s48, s44, s35
    s_waitcnt vmcnt(27)
    buffer_load_dwordx4 v12, s[24:27], s48 offen offset:0 nt lds
    s_max_i32 s47, s47, 15
    s_min_i32 s93, s47, 31
    s_xor_b32 s44, s44, s39
    s_add_u32 s44, s44, 16384
    s_xor_b32 s44, s44, s39
    s_waitcnt vmcnt(27)
    buffer_load_dwordx4 v13, s[24:27], s48 offen offset:1024 nt lds
    s_cmp_gt_i32 s93, 23
    s_cselect_b32 s47, 3, 0
    s_or_b32 s93, s93, s47
    s_add_u32 s46, s46, 16384
    s_and_b32 s46, s46, 65535
    s_waitcnt vmcnt(27)
    buffer_load_dwordx4 v14, s[24:27], s48 offen offset:2048 nt lds
    s_add_u32 s50, s50, 1
    s_cmp_eq_u32 s50, s56
    s_waitcnt vmcnt(27)
    buffer_load_dwordx4 v15, s[24:27], s48 offen offset:3072 nt lds
    s_cbranch_scc1 L_event
    s_cmp_eq_u32 s93, 27
    s_cbranch_scc1 L_it27
    s_cmp_eq_u32 s93, 31
    s_cbranch_scc1 L_it31
    s_cmp_eq_u32 s93, 23
    s_cbranch_scc1 L_it23
    s_branch L_disp
L_it31:
    s_add_u32 m0, s46, 0
    s_add_u32 s48, s44, s32
    s_waitcnt vmcnt(31)
    buffer_load_dwordx4 v8, s[24:27], s48 offen offset:0 nt lds
    s_waitcnt vmcnt(31)
    buffer_load_dwordx4 v9, s[24:27], s48 offen offset:1024 nt lds
    s_waitcnt vmcnt(31)
    buffer_load_dwordx4 v10, s[24:27], s48 offen offset:2048 nt lds
    s_waitcnt vmcnt(31)
    buffer_load_dwordx4 v11, s[24:27], s48 offen offset:3072 nt lds
    s_add_u32 m0, s46, 4096
    s_add_u32 s48, s44, s33
    s_waitcnt vmcnt(31)
    buffer_load_dwordx4 v12, s[24:27], s48 offen offset:0 nt lds
    s_waitcnt vmcnt(31)
    buffer_load_dwordx4 v13, s[24:27], s48 offen offset:1024 nt lds
    s_waitcnt vmcnt(31)
    buffer_load_dwordx4 v14, s[24:27], s48 offen offset:2048 nt lds
    s_waitcnt vmcnt(31)
    buffer_load_dwordx4 v15, s[24:27], s48 offen offset:3072 nt lds
    s_add_u32 m0, s46, 8192
    s_add_u32 s48, s44, s34
    s_waitcnt vmcnt(31)
    s_memrealtime s[80:81]
    buffer_load_dwordx4 v8, s[24:27], s48 offen offset:0 nt lds
    s_waitcnt vmcnt(31)
    buffer_load_dwordx4 v9, s[24:27], s48 offen offset:1024 nt lds
    s_waitcnt lgkmcnt(0)
    s_add_u32 s80, s80, 0x29
    s_lshl_b32 s47, s80, 4
    s_sub_i32 s47, s47, s52
    s_add_u32 s52, s52, s53
    s_waitcnt vmcnt(31)
    buffer_load_dwordx4 v10, s[24:27], s48 offen offset:2048 nt lds
    s_ashr_i32 s49, s47, 1
    s_max_i32 s47, s47, s49
    s_max_i32 s47, s47, -1280
    s_mul_i32 s47, s47, s54
    s_add_i32 s47, s47, s55
    s_ashr_i32 s47, s47, 13
    s_waitcnt vmcnt(31)
    buffer_load_dwordx4 v11, s[24:27], s48 offen offset:3072 nt lds
    s_add_u32 m0, s46, 12288
    s_add_u32 s48, s44, s35
    s_waitcnt vmcnt(31)
    buffer_load_dwordx4 v12, s[24:27], s48 offen offset:0 nt lds
    s_max_i32 s47, s47, 15
    s_min_i32 s93, s47, 31
    s_xor_b32 s44, s44, s39
    s_add_u32 s44, s44, 16384
    s_xor_b32 s44, s44, s39
    s_waitcnt vmcnt(31)
    buffer_load_dwordx4 v13, s[24:27], s48 offen offset:1024 nt lds
    s_cmp_gt_i32 s93, 23
    s_cselect_b32 s47, 3, 0
    s_or_b32 s93, s93, s47
    s_add_u32 s46, s46, 16384
    s_and_b32 s46, s46, 65535
    s_waitcnt vmcnt(31)
    buffer_load_dwordx4 v14, s[24:27], s48 offen offset:2048 nt lds
    s_add_u32 s50, s50, 1
    s_cmp_eq_u32 s50, s56
    s_waitcnt vmcnt(31)
    s_barrier
    buffer_load_dwordx4 v15, s[24:27], s48 offen offset:3072 nt lds
    s_cbranch_scc1 L_event
    s_cmp_eq_u32 s93, 31
    s_cbranch_scc1 L_it31
    s_cmp_eq_u32 s93, 27
    s_cbranch_scc1 L_it27
    s_branch L_disp
L_drain:
    s_waitcnt vmcnt(16)
    s_barrier
    s_waitcnt vmcnt(0) lgkmcnt(0)
    s_barrier
    s_movk_i32 s45, 0x100
    s_branch L_recv
L_worker:
    s_and_b32 s43, s40, 3
    v_and_b32 v8, 31, v0
    v_lshrrev_b32 v9, 5, v0
    s_cmp_ge_u32 s3, 4
    s_cbranch_scc1 L_pv
    s_sub_u32 s39, s3, 1
    v_lshlrev_b32 v2, 3, v0
    v_lshlrev_b32 v3, 4, v0
    v_and_b32 v12, 15, v8
    v_xor_b32 v11, v12, v9
    v_lshlrev_b32 v11, 4, v11
    v_lshl_or_b32 v11, v8, 8, v11
    v_add_u32 v11, 49152, v11
    v_lshlrev_b32 v13, 1, v9
    v_xor_b32 v12, v12, v13
    v_lshlrev_b32 v12, 4, v12
    v_lshlrev_b32 v1, 6, v9
    v_add_u32 v1, 65536, v1
    s_lshl_b32 s47, s39, 9
    s_add_u32 s48, s47, 98304
    v_add_u32 v85, s48, v2
    s_sub_u32 s48, s48, 512
    s_cmp_eq_u32 s39, 0
    s_cselect_b32 s48, 99328, s48
    v_add_u32 v84, s48, v2
    s_lshl_b32 s47, s39, 10
    s_add_u32 s48, s47, 99840
    v_add_u32 v88, s48, v2
    v_lshlrev_b32 v89, 2, v0
    v_mov_b32 v4, 0xff800000
    v_mov_b32 v5, 0xff800000
    v_mov_b32 v6, 0
    v_mov_b32 v7, 0
    s_waitcnt lgkmcnt(0)
    ds_write_b64 v85, v[4:5]
    v_lshl_or_b32 v0, v8, 9, v12
    s_mov_b32 s52, 0x3e0293ee
    v_xor_b32 v33, 32, v11
    v_xor_b32 v34, 64, v11
    v_xor_b32 v35, 96, v11
    v_xor_b32 v36, 128, v11
    v_xor_b32 v37, 160, v11
    v_xor_b32 v38, 192, v11
    v_xor_b32 v39, 224, v11
    s_waitcnt lgkmcnt(0)
    s_barrier
    s_barrier
    ds_read_b128 a[0:3], v11 offset:0
    ds_read_b128 a[4:7], v33 offset:0
    ds_read_b128 a[8:11], v34 offset:0
    ds_read_b128 a[12:15], v35 offset:0
    ds_read_b128 a[16:19], v36 offset:0
    ds_read_b128 a[20:23], v37 offset:0
    ds_read_b128 a[24:27], v38 offset:0
    ds_read_b128 a[28:31], v39 offset:0
    ds_read_b128 a[32:35], v11 offset:8192
    ds_read_b128 a[36:39], v33 offset:8192
    ds_read_b128 a[40:43], v34 offset:8192
    ds_read_b128 a[44:47], v35 offset:8192
    ds_read_b128 a[48:51], v36 offset:8192
    ds_read_b128 a[52:55], v37 offset:8192
    ds_read_b128 a[56:59], v38 offset:8192
    s_waitcnt lgkmcnt(8)
    ds_read_b128 a[60:63], v39 offset:8192
    s_mov_b32 s50, s39
    s_mov_b32 s45, 0
L_tile:
    s_mul_i32 s47, s50, 47
    s_lshr_b32 s47, s47, 10
    s_mul_i32 s47, s47, 22
    s_add_u32 s44, s50, s47
    s_cmp_ge_u32 s47, 44
    s_cselect_b32 s56, 20, 22
    s_lshl_b32 s57, s47, 1
    s_add_u32 s57, s57, s56
    s_sub_u32 s55, s50, s47
    s_sub_u32 s47, s50, s47
    s_cmp_ge_u32 s47, 13
    s_cselect_b32 s46, 13, 0
    s_sub_u32 s47, s47, s46
    s_mul_i32 s47, s47, 4608
    s_add_u32 s46, s47, 103440
    s_xor_b32 s49, s50, s38
    s_and_b32 s49, s49, 63
    s_lshr_b32 s51, s49, 2
    s_lshl_b32 s51, s51, 10
    s_and_b32 s47, s44, 3
    s_lshl_b32 s47, s47, 14
    s_waitcnt lgkmcnt(0)
    v_add_u32 v24, s51, v1
    v_add_u32 v8, s47, v0
    v_xor_b32 v9, 16, v8
    v_xor_b32 v10, 64, v8
    v_xor_b32 v11, 80, v8
    v_xor_b32 v12, 128, v8
    v_xor_b32 v13, 144, v8
    v_xor_b32 v14, 192, v8
    v_xor_b32 v15, 208, v8
    v_add_u32 v87, s46, v3
    v_add_u32 v86, s46, v89
    ds_read_b128 v[40:43], v24 offset:0
    ds_read_b128 v[44:47], v24 offset:16
    ds_read_b128 v[48:51], v24 offset:32
    ds_read_b128 v[52:55], v24 offset:48
    ds_read_b128 v[64:67], v24 offset:128
    ds_read_b128 v[68:71], v24 offset:144
    ds_read_b128 v[72:75], v24 offset:160
    ds_read_b128 v[76:79], v24 offset:176
L_qadv:
    s_cmp_ge_u32 s45, s44
    s_cbranch_scc1 L_qadv_d
    s_barrier
    s_add_u32 s45, s45, 1
    s_branch L_qadv
L_qadv_d:
    s_add_u32 s45, s45, 3
    s_barrier
    ds_read_b128 v[32:35], v8 offset:0
    ds_read_b128 v[36:39], v9 offset:0
    ds_read_b128 v[56:59], v10 offset:0
    ds_read_b128 v[60:63], v11 offset:0
    s_waitcnt lgkmcnt(2)
    v_cvt_f32_i32 v32, v32
    v_cvt_f32_i32 v33, v33
    v_cvt_f32_i32 v34, v34
    v_cvt_f32_i32 v35, v35
    v_pk_fma_f32 v[32:33], v[32:33], v[40:41], v[44:45]
    v_pk_fma_f32 v[34:35], v[34:35], v[42:43], v[46:47]
    v_cvt_f32_i32 v36, v36
    v_cvt_f32_i32 v37, v37
    v_cvt_f32_i32 v38, v38
    v_cvt_f32_i32 v39, v39
    v_pk_fma_f32 v[36:37], v[36:37], v[48:49], v[52:53]
    v_pk_fma_f32 v[38:39], v[38:39], v[50:51], v[54:55]
    v_cvt_pk_bf16_f32 v16, v32, v33
    v_cvt_pk_bf16_f32 v17, v34, v35
    v_cvt_pk_bf16_f32 v18, v36, v37
    v_cvt_pk_bf16_f32 v19, v38, v39
    ds_read_b128 v[32:35], v12 offset:0
    ds_read_b128 v[36:39], v13 offset:0
    ds_read_b128 v[40:43], v24 offset:256
    ds_read_b128 v[44:47], v24 offset:272
    ds_read_b128 v[48:51], v24 offset:288
    ds_read_b128 v[52:55], v24 offset:304
    s_waitcnt lgkmcnt(6)
    v_cvt_f32_i32 v56, v56
    v_cvt_f32_i32 v57, v57
    v_cvt_f32_i32 v58, v58
    v_cvt_f32_i32 v59, v59
    v_pk_fma_f32 v[56:57], v[56:57], v[64:65], v[68:69]
    v_pk_fma_f32 v[58:59], v[58:59], v[66:67], v[70:71]
    v_mfma_f32_32x32x16_bf16 v[96:111], v[16:19], a[0:3], 0
    v_cvt_f32_i32 v60, v60
    v_cvt_f32_i32 v61, v61
    v_cvt_f32_i32 v62, v62
    v_cvt_f32_i32 v63, v63
    v_pk_fma_f32 v[60:61], v[60:61], v[72:73], v[76:77]
    v_pk_fma_f32 v[62:63], v[62:63], v[74:75], v[78:79]
    v_cvt_pk_bf16_f32 v20, v56, v57
    v_cvt_pk_bf16_f32 v21, v58, v59
    v_mfma_f32_32x32x16_bf16 v[112:127], v[16:19], a[32:35], 0
    v_cvt_pk_bf16_f32 v22, v60, v61
    v_cvt_pk_bf16_f32 v23, v62, v63
    ds_read_b128 v[56:59], v14 offset:0
    ds_read_b128 v[60:63], v15 offset:0
    ds_read_b128 v[64:67], v24 offset:384
    ds_read_b128 v[68:71], v24 offset:400
    ds_read_b128 v[72:75], v24 offset:416
    ds_read_b128 v[76:79], v24 offset:432
    s_waitcnt lgkmcnt(6)
    v_cvt_f32_i32 v32, v32
    v_cvt_f32_i32 v33, v33
    v_cvt_f32_i32 v34, v34
    v_cvt_f32_i32 v35, v35
    v_pk_fma_f32 v[32:33], v[32:33], v[40:41], v[44:45]
    v_pk_fma_f32 v[34:35], v[34:35], v[42:43], v[46:47]
    v_mfma_f32_32x32x16_bf16 v[96:111], v[20:23], a[4:7], v[96:111]
    v_cvt_f32_i32 v36, v36
    v_cvt_f32_i32 v37, v37
    v_cvt_f32_i32 v38, v38
    v_cvt_f32_i32 v39, v39
    v_pk_fma_f32 v[36:37], v[36:37], v[48:49], v[52:53]
    v_pk_fma_f32 v[38:39], v[38:39], v[50:51], v[54:55]
    v_cvt_pk_bf16_f32 v16, v32, v33
    v_cvt_pk_bf16_f32 v17, v34, v35
    v_mfma_f32_32x32x16_bf16 v[112:127], v[20:23], a[36:39], v[112:127]
    v_cvt_pk_bf16_f32 v18, v36, v37
    v_cvt_pk_bf16_f32 v19, v38, v39
    ds_read_b128 v[32:35], v8 offset:256
    ds_read_b128 v[36:39], v9 offset:256
    ds_read_b128 v[40:43], v24 offset:512
    ds_read_b128 v[44:47], v24 offset:528
    ds_read_b128 v[48:51], v24 offset:544
    ds_read_b128 v[52:55], v24 offset:560
    s_waitcnt lgkmcnt(6)
    v_cvt_f32_i32 v56, v56
    v_cvt_f32_i32 v57, v57
    v_cvt_f32_i32 v58, v58
    v_cvt_f32_i32 v59, v59
    v_pk_fma_f32 v[56:57], v[56:57], v[64:65], v[68:69]
    v_pk_fma_f32 v[58:59], v[58:59], v[66:67], v[70:71]
    v_mfma_f32_32x32x16_bf16 v[96:111], v[16:19], a[8:11], v[96:111]
    v_cvt_f32_i32 v60, v60
    v_cvt_f32_i32 v61, v61
    v_cvt_f32_i32 v62, v62
    v_cvt_f32_i32 v63, v63
    v_pk_fma_f32 v[60:61], v[60:61], v[72:73], v[76:77]
    v_pk_fma_f32 v[62:63], v[62:63], v[74:75], v[78:79]
    v_cvt_pk_bf16_f32 v20, v56, v57
    v_cvt_pk_bf16_f32 v21, v58, v59
    v_mfma_f32_32x32x16_bf16 v[112:127], v[16:19], a[40:43], v[112:127]
    v_cvt_pk_bf16_f32 v22, v60, v61
    v_cvt_pk_bf16_f32 v23, v62, v63
    ds_read_b128 v[56:59], v10 offset:256
    ds_read_b128 v[60:63], v11 offset:256
    ds_read_b128 v[64:67], v24 offset:640
    ds_read_b128 v[68:71], v24 offset:656
    ds_read_b128 v[72:75], v24 offset:672
    ds_read_b128 v[76:79], v24 offset:688
    s_waitcnt lgkmcnt(6)
    v_cvt_f32_i32 v32, v32
    v_cvt_f32_i32 v33, v33
    v_cvt_f32_i32 v34, v34
    v_cvt_f32_i32 v35, v35
    v_pk_fma_f32 v[32:33], v[32:33], v[40:41], v[44:45]
    v_pk_fma_f32 v[34:35], v[34:35], v[42:43], v[46:47]
    v_mfma_f32_32x32x16_bf16 v[96:111], v[20:23], a[12:15], v[96:111]
    v_cvt_f32_i32 v36, v36
    v_cvt_f32_i32 v37, v37
    v_cvt_f32_i32 v38, v38
    v_cvt_f32_i32 v39, v39
    v_pk_fma_f32 v[36:37], v[36:37], v[48:49], v[52:53]
    v_pk_fma_f32 v[38:39], v[38:39], v[50:51], v[54:55]
    v_cvt_pk_bf16_f32 v16, v32, v33
    v_cvt_pk_bf16_f32 v17, v34, v35
    v_mfma_f32_32x32x16_bf16 v[112:127], v[20:23], a[44:47], v[112:127]
    v_cvt_pk_bf16_f32 v18, v36, v37
    v_cvt_pk_bf16_f32 v19, v38, v39
    ds_read_b128 v[32:35], v12 offset:256
    ds_read_b128 v[36:39], v13 offset:256
    ds_read_b128 v[128:131], v14 offset:256
    ds_read_b128 v[132:135], v15 offset:256
    ds_read_b128 v[40:43], v24 offset:768
    ds_read_b128 v[44:47], v24 offset:784
    ds_read_b128 v[48:51], v24 offset:800
    ds_read_b128 v[52:55], v24 offset:816
    s_waitcnt lgkmcnt(8)
    v_cvt_f32_i32 v56, v56
    v_cvt_f32_i32 v57, v57
    v_cvt_f32_i32 v58, v58
    v_cvt_f32_i32 v59, v59
    v_pk_fma_f32 v[56:57], v[56:57], v[64:65], v[68:69]
    v_pk_fma_f32 v[58:59], v[58:59], v[66:67], v[70:71]
    v_mfma_f32_32x32x16_bf16 v[96:111], v[16:19], a[16:19], v[96:111]
    v_cvt_f32_i32 v60, v60
    v_cvt_f32_i32 v61, v61
    v_cvt_f32_i32 v62, v62
    v_cvt_f32_i32 v63, v63
    v_pk_fma_f32 v[60:61], v[60:61], v[72:73], v[76:77]
    v_pk_fma_f32 v[62:63], v[62:63], v[74:75], v[78:79]
    v_cvt_pk_bf16_f32 v20, v56, v57
    v_cvt_pk_bf16_f32 v21, v58, v59
    v_mfma_f32_32x32x16_bf16 v[112:127], v[16:19], a[48:51], v[112:127]
    v_cvt_pk_bf16_f32 v22, v60, v61
    v_cvt_pk_bf16_f32 v23, v62, v63
    s_waitcnt lgkmcnt(4)
    s_barrier
    ds_read_b128 v[64:67], v24 offset:896
    ds_read_b128 v[68:71], v24 offset:912
    ds_read_b128 v[72:75], v24 offset:928
    ds_read_b128 v[76:79], v24 offset:944
    ds_read_b64 v[82:83], v84
    s_waitcnt lgkmcnt(5)
    v_cvt_f32_i32 v32, v32
    v_cvt_f32_i32 v33, v33
    v_cvt_f32_i32 v34, v34
    v_cvt_f32_i32 v35, v35
    v_pk_fma_f32 v[32:33], v[32:33], v[40:41], v[44:45]
    v_pk_fma_f32 v[34:35], v[34:35], v[42:43], v[46:47]
    v_mfma_f32_32x32x16_bf16 v[96:111], v[20:23], a[20:23], v[96:111]
    v_cvt_f32_i32 v36, v36
    v_cvt_f32_i32 v37, v37
    v_cvt_f32_i32 v38, v38
    v_cvt_f32_i32 v39, v39
    v_pk_fma_f32 v[36:37], v[36:37], v[48:49], v[52:53]
    v_pk_fma_f32 v[38:39], v[38:39], v[50:51], v[54:55]
    v_cvt_pk_bf16_f32 v16, v32, v33
    v_cvt_pk_bf16_f32 v17, v34, v35
    v_mfma_f32_32x32x16_bf16 v[112:127], v[20:23], a[52:55], v[112:127]
    v_cvt_pk_bf16_f32 v18, v36, v37
    v_cvt_pk_bf16_f32 v19, v38, v39
    s_waitcnt lgkmcnt(1)
    v_cvt_f32_i32 v128, v128
    v_cvt_f32_i32 v129, v129
    v_cvt_f32_i32 v130, v130
    v_cvt_f32_i32 v131, v131
    v_pk_fma_f32 v[128:129], v[128:129], v[64:65], v[68:69]
    v_pk_fma_f32 v[130:131], v[130:131], v[66:67], v[70:71]
    v_mfma_f32_32x32x16_bf16 v[96:111], v[16:19], a[24:27], v[96:111]
    v_cvt_f32_i32 v132, v132
    v_cvt_f32_i32 v133, v133
    v_cvt_f32_i32 v134, v134
    v_cvt_f32_i32 v135, v135
    v_pk_fma_f32 v[132:133], v[132:133], v[72:73], v[76:77]
    v_pk_fma_f32 v[134:135], v[134:135], v[74:75], v[78:79]
    v_cvt_pk_bf16_f32 v20, v128, v129
    v_cvt_pk_bf16_f32 v21, v130, v131
    v_mfma_f32_32x32x16_bf16 v[112:127], v[16:19], a[56:59], v[112:127]
    v_cvt_pk_bf16_f32 v22, v132, v133
    v_cvt_pk_bf16_f32 v23, v134, v135
    s_nop 1
    v_mfma_f32_32x32x16_bf16 v[96:111], v[20:23], a[28:31], v[96:111]
    v_mfma_f32_32x32x16_bf16 v[112:127], v[20:23], a[60:63], v[112:127]
    s_nop 10
    v_max3_f32 v24, v96, v97, v98
    v_max3_f32 v26, v99, v100, v101
    v_max3_f32 v24, v24, v102, v103
    v_max3_f32 v26, v26, v104, v105
    v_max3_f32 v24, v24, v106, v107
    v_max3_f32 v26, v26, v108, v109
    v_max3_f32 v24, v24, v110, v111
    v_max_f32 v24, v24, v26
    v_max3_f32 v25, v112, v113, v114
    v_max3_f32 v27, v115, v116, v117
    v_max3_f32 v25, v25, v118, v119
    v_max3_f32 v27, v27, v120, v121
    v_max3_f32 v25, v25, v122, v123
    v_max3_f32 v27, v27, v124, v125
    v_max3_f32 v25, v25, v126, v127
    v_max_f32 v25, v25, v27
    v_mov_b32 v26, v24
    v_mov_b32 v27, v25
    s_nop 1
    v_permlane32_swap_b32 v24, v26
    v_permlane32_swap_b32 v25, v27
    v_max_f32 v24, v24, v26
    v_max_f32 v25, v25, v27
    v_mul_f32 v24, s52, v24
    v_mul_f32 v25, s52, v25
    s_waitcnt lgkmcnt(0)
    v_max3_f32 v24, v24, v4, v82
    v_max3_f32 v25, v25, v5, v83
    v_sub_f32 v82, v82, v24
    v_sub_f32 v83, v83, v25
    v_sub_f32 v28, v4, v24
    v_sub_f32 v29, v5, v25
    v_exp_f32 v82, v82
    v_exp_f32 v83, v83
    v_exp_f32 v28, v28
    v_exp_f32 v29, v29
    v_mov_b32 v4, v24
    v_mov_b32 v5, v25
    ds_write_b64 v85, v[4:5]
    v_mul_f32 v6, v6, v28
    v_mul_f32 v7, v7, v29
    v_fma_f32 v96, v96, s52, -v4
    v_fma_f32 v97, v97, s52, -v4
    v_fma_f32 v98, v98, s52, -v4
    v_fma_f32 v99, v99, s52, -v4
    v_fma_f32 v100, v100, s52, -v4
    v_fma_f32 v101, v101, s52, -v4
    v_fma_f32 v102, v102, s52, -v4
    v_fma_f32 v103, v103, s52, -v4
    v_fma_f32 v104, v104, s52, -v4
    v_fma_f32 v105, v105, s52, -v4
    v_fma_f32 v106, v106, s52, -v4
    v_fma_f32 v107, v107, s52, -v4
    v_fma_f32 v108, v108, s52, -v4
    v_fma_f32 v109, v109, s52, -v4
    v_fma_f32 v110, v110, s52, -v4
    v_fma_f32 v111, v111, s52, -v4
    v_exp_f32 v96, v96
    v_exp_f32 v97, v97
    v_exp_f32 v98, v98
    v_exp_f32 v99, v99
    v_exp_f32 v100, v100
    v_exp_f32 v101, v101
    v_exp_f32 v102, v102
    v_exp_f32 v103, v103
    v_exp_f32 v104, v104
    v_exp_f32 v105, v105
    v_exp_f32 v106, v106
    v_exp_f32 v107, v107
    v_exp_f32 v108, v108
    v_exp_f32 v109, v109
    v_exp_f32 v110, v110
    v_exp_f32 v111, v111
    s_waitcnt lgkmcnt(0)
    s_barrier
    v_cvt_pk_bf16_f32 v8, v96, v97
    v_cvt_pk_bf16_f32 v9, v98, v99
    v_cvt_pk_bf16_f32 v10, v100, v101
    v_cvt_pk_bf16_f32 v11, v102, v103
    v_cvt_pk_bf16_f32 v12, v104, v105
    v_cvt_pk_bf16_f32 v13, v106, v107
    v_cvt_pk_bf16_f32 v14, v108, v109
    v_cvt_pk_bf16_f32 v15, v110, v111
    v_fma_f32 v112, v112, s52, -v5
    v_fma_f32 v113, v113, s52, -v5
    v_fma_f32 v114, v114, s52, -v5
    v_fma_f32 v115, v115, s52, -v5
    v_fma_f32 v116, v116, s52, -v5
    v_fma_f32 v117, v117, s52, -v5
    v_fma_f32 v118, v118, s52, -v5
    v_fma_f32 v119, v119, s52, -v5
    v_fma_f32 v120, v120, s52, -v5
    v_fma_f32 v121, v121, s52, -v5
    v_fma_f32 v122, v122, s52, -v5
    v_fma_f32 v123, v123, s52, -v5
    v_fma_f32 v124, v124, s52, -v5
    v_fma_f32 v125, v125, s52, -v5
    v_fma_f32 v126, v126, s52, -v5
    v_fma_f32 v127, v127, s52, -v5
    v_exp_f32 v112, v112
    v_exp_f32 v113, v113
    v_exp_f32 v114, v114
    v_exp_f32 v115, v115
    v_exp_f32 v116, v116
    v_exp_f32 v117, v117
    v_exp_f32 v118, v118
    v_exp_f32 v119, v119
    v_exp_f32 v120, v120
    v_exp_f32 v121, v121
    v_exp_f32 v122, v122
    v_exp_f32 v123, v123
    v_exp_f32 v124, v124
    v_exp_f32 v125, v125
    v_exp_f32 v126, v126
    v_exp_f32 v127, v127
    v_cvt_pk_bf16_f32 v16, v112, v113
    v_cvt_pk_bf16_f32 v17, v114, v115
    v_cvt_pk_bf16_f32 v18, v116, v117
    v_cvt_pk_bf16_f32 v19, v118, v119
    v_cvt_pk_bf16_f32 v20, v120, v121
    v_cvt_pk_bf16_f32 v21, v122, v123
    v_cvt_pk_bf16_f32 v22, v124, v125
    v_cvt_pk_bf16_f32 v23, v126, v127
    s_cmp_ge_u32 s55, 13
    s_cbranch_scc1 L_nowr
    ds_write_b128 v87, v[8:11] offset:0
    ds_write_b128 v87, v[12:15] offset:1024
    ds_write_b128 v87, v[16:19] offset:2048
    ds_write_b128 v87, v[20:23] offset:3072
    ds_write2st64_b32 v86, v82, v83 offset0:16 offset1:17
L_nowr:
    v_pk_add_f32 v[96:97], v[96:97], v[104:105]
    v_pk_add_f32 v[98:99], v[98:99], v[106:107]
    v_pk_add_f32 v[100:101], v[100:101], v[108:109]
    v_pk_add_f32 v[102:103], v[102:103], v[110:111]
    v_pk_add_f32 v[96:97], v[96:97], v[100:101]
    v_pk_add_f32 v[98:99], v[98:99], v[102:103]
    v_pk_add_f32 v[96:97], v[96:97], v[98:99]
    v_add_f32 v6, v6, v96
    v_add_f32 v6, v6, v97
    v_pk_add_f32 v[112:113], v[112:113], v[120:121]
    v_pk_add_f32 v[114:115], v[114:115], v[122:123]
    v_pk_add_f32 v[116:117], v[116:117], v[124:125]
    v_pk_add_f32 v[118:119], v[118:119], v[126:127]
    v_pk_add_f32 v[112:113], v[112:113], v[116:117]
    v_pk_add_f32 v[114:115], v[114:115], v[118:119]
    v_pk_add_f32 v[112:113], v[112:113], v[114:115]
    v_add_f32 v7, v7, v112
    v_add_f32 v7, v7, v113
    v_mov_b32 v24, v6
    v_mov_b32 v25, v7
    v_mov_b32 v26, v6
    v_mov_b32 v27, v7
    v_mov_b32 v28, v4
    v_mov_b32 v30, v5
    v_permlane32_swap_b32 v24, v26
    v_permlane32_swap_b32 v25, v27
    v_add_f32 v29, v24, v26
    v_add_f32 v31, v25, v27
    ds_write2st64_b64 v88, v[28:29], v[30:31] offset0:0 offset1:1
    s_add_u32 s50, s50, 3
    s_cmp_lt_u32 s55, 13
    s_cbranch_scc1 L_tile
    s_sub_u32 s47, s56, s55
    s_cmp_le_u32 s47, 3
    s_cbranch_scc1 L_wback
    s_cmp_le_u32 s47, 6
    s_cbranch_scc1 L_parkA
    v_accvgpr_write_b32 a84, v8
    v_accvgpr_write_b32 a85, v9
    v_accvgpr_write_b32 a86, v10
    v_accvgpr_write_b32 a87, v11
    v_accvgpr_write_b32 a88, v12
    v_accvgpr_write_b32 a89, v13
    v_accvgpr_write_b32 a90, v14
    v_accvgpr_write_b32 a91, v15
    v_accvgpr_write_b32 a92, v16
    v_accvgpr_write_b32 a93, v17
    v_accvgpr_write_b32 a94, v18
    v_accvgpr_write_b32 a95, v19
    v_accvgpr_write_b32 a96, v20
    v_accvgpr_write_b32 a97, v21
    v_accvgpr_write_b32 a98, v22
    v_accvgpr_write_b32 a99, v23
    v_accvgpr_write_b32 a100, v82
    v_accvgpr_write_b32 a101, v83
    s_branch L_tile
L_parkA:
    v_accvgpr_write_b32 a64, v8
    v_accvgpr_write_b32 a65, v9
    v_accvgpr_write_b32 a66, v10
    v_accvgpr_write_b32 a67, v11
    v_accvgpr_write_b32 a68, v12
    v_accvgpr_write_b32 a69, v13
    v_accvgpr_write_b32 a70, v14
    v_accvgpr_write_b32 a71, v15
    v_accvgpr_write_b32 a72, v16
    v_accvgpr_write_b32 a73, v17
    v_accvgpr_write_b32 a74, v18
    v_accvgpr_write_b32 a75, v19
    v_accvgpr_write_b32 a76, v20
    v_accvgpr_write_b32 a77, v21
    v_accvgpr_write_b32 a78, v22
    v_accvgpr_write_b32 a79, v23
    v_accvgpr_write_b32 a80, v82
    v_accvgpr_write_b32 a81, v83
    s_branch L_tile
L_wback:
    s_add_u32 s57, s57, 9
    s_waitcnt lgkmcnt(0)
L_qwb:
    s_cmp_ge_u32 s45, s57
    s_cbranch_scc1 L_qwb_d
    s_barrier
    s_add_u32 s45, s45, 1
    s_branch L_qwb
L_qwb_d:
    ds_write_b128 v87, v[8:11] offset:0
    ds_write_b128 v87, v[12:15] offset:1024
    ds_write_b128 v87, v[16:19] offset:2048
    ds_write_b128 v87, v[20:23] offset:3072
    ds_write2st64_b32 v86, v82, v83 offset0:16 offset1:17
    s_cmp_lt_u32 s55, 16
    s_cbranch_scc1 L_wbdone
    s_barrier
    s_add_u32 s45, s45, 1
    v_subrev_u32 v87, 13824, v87
    v_subrev_u32 v86, 13824, v86
    ds_write_b128 v87, a[64:67] offset:0
    ds_write_b128 v87, a[68:71] offset:1024
    ds_write_b128 v87, a[72:75] offset:2048
    ds_write_b128 v87, a[76:79] offset:3072
    ds_write2st64_b32 v86, a80, a81 offset0:16 offset1:17
    s_cmp_lt_u32 s55, 19
    s_cbranch_scc1 L_wbdone
    s_barrier
    s_add_u32 s45, s45, 1
    v_subrev_u32 v87, 13824, v87
    v_subrev_u32 v86, 13824, v86
    ds_write_b128 v87, a[84:87] offset:0
    ds_write_b128 v87, a[88:91] offset:1024
    ds_write_b128 v87, a[92:95] offset:2048
    ds_write_b128 v87, a[96:99] offset:3072
    ds_write2st64_b32 v86, a100, a101 offset0:16 offset1:17
L_wbdone:
    s_cmp_lt_u32 s50, 64
    s_cbranch_scc1 L_tile
    s_waitcnt lgkmcnt(0)
L_qend0:
    s_cmp_ge_u32 s45, 127
    s_cbranch_scc1 L_qend0_d
    s_barrier
    s_add_u32 s45, s45, 1
    s_branch L_qend0
L_qend0_d:
    s_cmp_lg_u32 s39, 0
    s_cbranch_scc1 L_qend
    s_lshl_b32 s42, s40, 10
    s_add_u32 s42, s42, 9437184
    v_lshl_add_u32 v8, v3, 3, s42
    s_mov_b64 exec, 240
    global_load_dword v9, v8, s[22:23] sc1
    s_mov_b64 exec, -1
L_qend:
    s_branch L_recv
L_pv:
    s_and_b32 s39, s3, 3
    s_xor_b32 s55, s39, s43
    s_lshr_b32 s56, s55, 1
    s_and_b32 s57, s55, 1
    v_lshlrev_b32 v1, 3, v8
    v_lshl_or_b32 v1, v9, 11, v1
    s_lshl_b32 s47, s57, 8
    v_add_u32 v1, s47, v1
    v_lshlrev_b32 v2, 5, v9
    v_add_u32 v2, 81920, v2
    s_lshl_b32 s47, s56, 11
    s_add_u32 s47, s47, 103440
    v_lshl_add_u32 v3, v0, 4, s47
    s_lshl_b32 s47, s56, 8
    s_add_u32 s47, s47, 107536
    v_lshl_add_u32 v4, v0, 2, s47
    v_mov_b32 v96, 0
    v_mov_b32 v97, 0
    v_mov_b32 v98, 0
    v_mov_b32 v99, 0
    v_mov_b32 v100, 0
    v_mov_b32 v101, 0
    v_mov_b32 v102, 0
    v_mov_b32 v103, 0
    v_mov_b32 v104, 0
    v_mov_b32 v105, 0
    v_mov_b32 v106, 0
    v_mov_b32 v107, 0
    v_mov_b32 v108, 0
    v_mov_b32 v109, 0
    v_mov_b32 v110, 0
    v_mov_b32 v111, 0
    v_mov_b32 v112, 0
    v_mov_b32 v113, 0
    v_mov_b32 v114, 0
    v_mov_b32 v115, 0
    v_mov_b32 v116, 0
    v_mov_b32 v117, 0
    v_mov_b32 v118, 0
    v_mov_b32 v119, 0
    v_mov_b32 v120, 0
    v_mov_b32 v121, 0
    v_mov_b32 v122, 0
    v_mov_b32 v123, 0
    v_mov_b32 v124, 0
    v_mov_b32 v125, 0
    v_mov_b32 v126, 0
    v_mov_b32 v127, 0
    s_lshl_b32 s47, s56, 9
    s_add_u32 s47, s47, 99840
    v_lshl_add_u32 v10, v0, 3, s47
    v_accvgpr_write_b32 a0, v10
    s_lshl_b32 s44, s41, 2
    s_or_b32 s44, s44, s55
    s_mul_i32 s42, s44, 3
    s_add_u32 s42, s42, s39
    s_max_u32 s42, s42, 1
    s_sub_u32 s42, s42, 1
    s_mul_i32 s42, s42, 4608
    s_lshl_b32 s44, s44, 10
    s_lshl_b32 s47, s43, 7
    s_add_u32 s44, s44, s47
    s_add_u32 s44, s44, 9437184
    s_waitcnt lgkmcnt(0)
    s_add_u32 s24, s22, s42
    s_addc_u32 s25, s23, 0
    s_and_b32 s25, s25, 0xffff
    s_mov_b32 s26, 4608
    s_mov_b32 s27, 0x20000
    s_mov_b32 s50, 0
    s_mov_b32 s45, 0
    s_lshl_b32 s58, s2, 2
    s_or_b32 s58, s58, s39
    s_cmp_lg_u32 s58, 0
    s_cbranch_scc1 L_noTag
    s_memrealtime s[48:49]
    v_lshlrev_b32 v15, 3, v0
    s_waitcnt lgkmcnt(0)
    s_lshl_b64 s[48:49], s[48:49], 1
    s_bitset1_b32 s48, 0
    s_bitset1_b32 s49, 31
    v_mov_b32 v16, s48
    v_mov_b32 v17, s49
    s_mov_b64 exec, 0xffff
    global_store_dwordx2 v15, v[16:17], s[20:21] sc1
    s_mov_b64 exec, -1
L_noTag:
    s_mov_b32 s54, 0xffff0000
    s_lshl_b32 s47, s39, 10
    s_add_u32 s47, s47, 32768
    v_lshl_add_u32 v12, v0, 4, s47
    s_lshl_b32 s47, s39, 12
    s_add_u32 s47, s47, 65536
    v_lshl_add_u32 v13, v0, 6, s47
    s_and_b32 s37, s2, 112
    s_bcnt1_i32_b32 s37, s37
    s_lshl_b32 s37, s37, 1
    s_and_b32 s37, s37, 2
    s_and_b32 s36, s2, 136
    s_bcnt1_i32_b32 s36, s36
    s_and_b32 s36, s36, 1
    s_or_b32 s37, s37, s36
    s_lshl_b32 s37, s37, 6
    v_xor_b32 v14, s37, v13
    s_barrier
    ds_read_b128 v[64:67], v12 offset:0
    ds_read_b128 v[68:71], v12 offset:4096
    ds_read_b128 v[72:75], v12 offset:8192
    ds_read_b128 v[76:79], v12 offset:12288
    s_waitcnt lgkmcnt(2)
    v_lshlrev_b32 v32, 16, v64
    v_lshlrev_b32 v36, 16, v68
    v_mul_f32_e64 v36, -v36, v32
    v_and_b32 v33, s54, v64
    v_and_b32 v37, s54, v68
    v_mul_f32_e64 v37, -v37, v33
    v_lshlrev_b32 v34, 16, v65
    v_lshlrev_b32 v38, 16, v69
    v_mul_f32_e64 v38, -v38, v34
    v_and_b32 v35, s54, v65
    v_and_b32 v39, s54, v69
    v_mul_f32_e64 v39, -v39, v35
    ds_write_b128 v13, v[32:35] offset:0
    ds_write_b128 v13, v[36:39] offset:16
    v_lshlrev_b32 v40, 16, v66
    v_lshlrev_b32 v44, 16, v70
    v_mul_f32_e64 v44, -v44, v40
    v_and_b32 v41, s54, v66
    v_and_b32 v45, s54, v70
    v_mul_f32_e64 v45, -v45, v41
    v_lshlrev_b32 v42, 16, v67
    v_lshlrev_b32 v46, 16, v71
    v_mul_f32_e64 v46, -v46, v42
    v_and_b32 v43, s54, v67
    v_and_b32 v47, s54, v71
    v_mul_f32_e64 v47, -v47, v43
    ds_write_b128 v13, v[40:43] offset:32
    ds_write_b128 v13, v[44:47] offset:48
    s_waitcnt lgkmcnt(0)
    s_barrier
    s_branch L_page
.p2align 12
L_page:
    v_lshlrev_b32 v48, 16, v72
    v_lshlrev_b32 v52, 16, v76
    v_mul_f32_e64 v52, -v52, v48
    v_and_b32 v49, s54, v72
    v_and_b32 v53, s54, v76
    v_mul_f32_e64 v53, -v53, v49
    v_lshlrev_b32 v50, 16, v73
    v_lshlrev_b32 v54, 16, v77
    v_mul_f32_e64 v54, -v54, v50
    v_and_b32 v51, s54, v73
    v_and_b32 v55, s54, v77
    v_mul_f32_e64 v55, -v55, v51
    ds_write_b128 v14, v[48:51] offset:16384
    ds_write_b128 v14, v[52:55] offset:16400
    v_lshlrev_b32 v56, 16, v74
    v_lshlrev_b32 v60, 16, v78
    v_mul_f32_e64 v60, -v60, v56
    v_and_b32 v57, s54, v74
    v_and_b32 v61, s54, v78
    v_mul_f32_e64 v61, -v61, v57
    v_lshlrev_b32 v58, 16, v75
    v_lshlrev_b32 v62, 16, v79
    v_mul_f32_e64 v62, -v62, v58
    v_and_b32 v59, s54, v75
    v_and_b32 v63, s54, v79
    v_mul_f32_e64 v63, -v63, v59
    ds_write_b128 v14, v[56:59] offset:16416
    ds_write_b128 v14, v[60:63] offset:16432
    s_waitcnt lgkmcnt(0)
L_pvrun:
    s_cmp_ge_u32 s50, 44
    s_cselect_b32 s47, 20, 22
    s_add_u32 s51, s50, s47
    s_add_u32 s48, s50, s51
    s_mov_b32 s46, 0
    s_cmp_lg_u32 s51, 64
    s_cbranch_scc1 L_pvwait
    s_cmp_lg_u32 s39, 0
    s_cbranch_scc1 L_pvwait
    v_mov_b32 v16, 0
    global_load_dwordx2 v[18:19], v16, s[20:21] sc1
    s_barrier
    s_barrier
    s_barrier
    s_add_u32 s45, s45, 3
    s_mov_b32 s49, 0x100000
L_annWait:
    s_waitcnt vmcnt(0)
    v_min_u32 v17, v18, v19
    s_sub_u32 s49, s49, 1
    s_cbranch_scc1 L_annDone
    v_readfirstlane_b32 s47, v17
    s_nop 1
    s_cmp_lg_u32 s47, 0
    s_cbranch_scc1 L_annDone
    global_load_dwordx2 v[18:19], v16, s[20:21] sc1
    s_branch L_annWait
L_annDone:
    v_mov_b32 v16, 103424
    v_mov_b32 v17, 0
    ds_write_b64 v16, v[18:19]
    ds_write_b32 v16, v17 offset:8
    s_waitcnt lgkmcnt(0)
L_pvwait:
    s_cmp_ge_u32 s45, s48
    s_cbranch_scc1 L_pvwait_d
    s_barrier
    s_add_u32 s45, s45, 1
    s_branch L_pvwait
L_pvwait_d:
    s_branch L_pvpre
L_pvtile:
    s_barrier
    ds_read2st64_b64 v[32:35], v5 offset0:0 offset1:1
    ds_read2st64_b64 v[36:39], v5 offset0:2 offset1:3
    ds_read2st64_b64 v[40:43], v5 offset0:8 offset1:9
    ds_read2st64_b64 v[44:47], v5 offset0:10 offset1:11
    ds_read2st64_b64 v[48:51], v5 offset0:16 offset1:17
    ds_read2st64_b64 v[52:55], v5 offset0:18 offset1:19
    ds_read2st64_b64 v[56:59], v5 offset0:24 offset1:25
    ds_read2st64_b64 v[60:63], v5 offset0:26 offset1:27
    s_waitcnt lgkmcnt(7)
    v_cvt_f32_i32 v32, v32
    v_cvt_f32_i32 v33, v33
    v_cvt_f32_i32 v34, v34
    v_cvt_f32_i32 v35, v35
    v_pk_fma_f32 v[32:33], v[32:33], v[64:65], v[68:69] op_sel:[0,0,0] op_sel_hi:[1,0,0]
    v_pk_fma_f32 v[34:35], v[34:35], v[64:65], v[68:69] op_sel:[0,1,1] op_sel_hi:[1,1,1]
    v_cvt_pk_bf16_f32 v16, v32, v34
    v_cvt_pk_bf16_f32 v20, v33, v35
    s_waitcnt lgkmcnt(6)
    v_cvt_f32_i32 v36, v36
    v_cvt_f32_i32 v37, v37
    v_cvt_f32_i32 v38, v38
    v_cvt_f32_i32 v39, v39
    v_pk_fma_f32 v[36:37], v[36:37], v[66:67], v[70:71] op_sel:[0,0,0] op_sel_hi:[1,0,0]
    v_pk_fma_f32 v[38:39], v[38:39], v[66:67], v[70:71] op_sel:[0,1,1] op_sel_hi:[1,1,1]
    v_cvt_pk_bf16_f32 v17, v36, v38
    v_cvt_pk_bf16_f32 v21, v37, v39
    s_waitcnt lgkmcnt(5)
    v_cvt_f32_i32 v40, v40
    v_cvt_f32_i32 v41, v41
    v_cvt_f32_i32 v42, v42
    v_cvt_f32_i32 v43, v43
    v_pk_fma_f32 v[40:41], v[40:41], v[72:73], v[76:77] op_sel:[0,0,0] op_sel_hi:[1,0,0]
    v_pk_fma_f32 v[42:43], v[42:43], v[72:73], v[76:77] op_sel:[0,1,1] op_sel_hi:[1,1,1]
    v_cvt_pk_bf16_f32 v18, v40, v42
    v_cvt_pk_bf16_f32 v22, v41, v43
    s_waitcnt lgkmcnt(4)
    v_cvt_f32_i32 v44, v44
    v_cvt_f32_i32 v45, v45
    v_cvt_f32_i32 v46, v46
    v_cvt_f32_i32 v47, v47
    v_pk_fma_f32 v[44:45], v[44:45], v[74:75], v[78:79] op_sel:[0,0,0] op_sel_hi:[1,0,0]
    v_pk_fma_f32 v[46:47], v[46:47], v[74:75], v[78:79] op_sel:[0,1,1] op_sel_hi:[1,1,1]
    v_cvt_pk_bf16_f32 v19, v44, v46
    v_cvt_pk_bf16_f32 v23, v45, v47
    s_waitcnt lgkmcnt(3)
    v_cvt_f32_i32 v48, v48
    v_cvt_f32_i32 v49, v49
    v_cvt_f32_i32 v50, v50
    v_cvt_f32_i32 v51, v51
    v_pk_fma_f32 v[48:49], v[48:49], v[80:81], v[84:85] op_sel:[0,0,0] op_sel_hi:[1,0,0]
    v_pk_fma_f32 v[50:51], v[50:51], v[80:81], v[84:85] op_sel:[0,1,1] op_sel_hi:[1,1,1]
    v_mfma_f32_32x32x16_bf16 v[96:111], v[16:19], v[8:11], v[96:111]
    v_cvt_pk_bf16_f32 v24, v48, v50
    v_cvt_pk_bf16_f32 v28, v49, v51
    s_waitcnt lgkmcnt(2)
    v_cvt_f32_i32 v52, v52
    v_cvt_f32_i32 v53, v53
    v_cvt_f32_i32 v54, v54
    v_cvt_f32_i32 v55, v55
    v_pk_fma_f32 v[52:53], v[52:53], v[82:83], v[86:87] op_sel:[0,0,0] op_sel_hi:[1,0,0]
    v_pk_fma_f32 v[54:55], v[54:55], v[82:83], v[86:87] op_sel:[0,1,1] op_sel_hi:[1,1,1]
    v_mfma_f32_32x32x16_bf16 v[112:127], v[20:23], v[8:11], v[112:127]
    v_cvt_pk_bf16_f32 v25, v52, v54
    v_cvt_pk_bf16_f32 v29, v53, v55
    s_waitcnt lgkmcnt(1)
    v_cvt_f32_i32 v56, v56
    v_cvt_f32_i32 v57, v57
    v_cvt_f32_i32 v58, v58
    v_cvt_f32_i32 v59, v59
    v_pk_fma_f32 v[56:57], v[56:57], v[88:89], v[92:93] op_sel:[0,0,0] op_sel_hi:[1,0,0]
    v_pk_fma_f32 v[58:59], v[58:59], v[88:89], v[92:93] op_sel:[0,1,1] op_sel_hi:[1,1,1]
    v_cvt_pk_bf16_f32 v26, v56, v58
    v_cvt_pk_bf16_f32 v30, v57, v59
    s_waitcnt lgkmcnt(0)
    v_cvt_f32_i32 v60, v60
    v_cvt_f32_i32 v61, v61
    v_cvt_f32_i32 v62, v62
    v_cvt_f32_i32 v63, v63
    v_pk_fma_f32 v[60:61], v[60:61], v[90:91], v[94:95] op_sel:[0,0,0] op_sel_hi:[1,0,0]
    v_pk_fma_f32 v[62:63], v[62:63], v[90:91], v[94:95] op_sel:[0,1,1] op_sel_hi:[1,1,1]
    v_cvt_pk_bf16_f32 v27, v60, v62
    v_cvt_pk_bf16_f32 v31, v61, v63
    s_add_u32 s50, s50, 1
    s_nop 0
    v_mfma_f32_32x32x16_bf16 v[96:111], v[24:27], v[12:15], v[96:111]
    v_mfma_f32_32x32x16_bf16 v[112:127], v[28:31], v[12:15], v[112:127]
    s_cmp_eq_u32 s50, 64
    s_cbranch_scc1 L_pvdone
    s_cmp_eq_u32 s50, s51
    s_cbranch_scc1 L_pvrun
    s_add_u32 s46, s46, 4608
    s_cmp_eq_u32 s46, 59904
    s_cselect_b32 s46, 0, s46
L_pvpre:
    v_add_u32 v7, s46, v4
    ds_read_b32 v6, v7
    v_add_u32 v7, s46, v3
    ds_read_b128 v[8:11], v7
    ds_read_b128 v[12:15], v7 offset:1024
L_pvgot:
    s_xor_b32 s49, s50, s38
    s_and_b32 s49, s49, 63
    s_lshl_b32 s49, s49, 8
    v_add_u32 v7, s49, v2
    ds_read_b128 v[64:67], v7 offset:0
    ds_read_b128 v[68:71], v7 offset:16
    ds_read_b128 v[72:75], v7 offset:64
    ds_read_b128 v[76:79], v7 offset:80
    ds_read_b128 v[80:83], v7 offset:128
    ds_read_b128 v[84:87], v7 offset:144
    ds_read_b128 v[88:91], v7 offset:192
    ds_read_b128 v[92:95], v7 offset:208
    s_and_b32 s47, s45, 3
    s_lshl_b32 s47, s47, 14
    v_add_u32 v5, s47, v1
    s_add_u32 s45, s45, 1
    s_waitcnt lgkmcnt(10)
    v_pk_mul_f32 v[96:97], v[96:97], v[6:7] op_sel_hi:[1,0]
    v_pk_mul_f32 v[98:99], v[98:99], v[6:7] op_sel_hi:[1,0]
    v_pk_mul_f32 v[100:101], v[100:101], v[6:7] op_sel_hi:[1,0]
    v_pk_mul_f32 v[102:103], v[102:103], v[6:7] op_sel_hi:[1,0]
    v_pk_mul_f32 v[104:105], v[104:105], v[6:7] op_sel_hi:[1,0]
    v_pk_mul_f32 v[106:107], v[106:107], v[6:7] op_sel_hi:[1,0]
    v_pk_mul_f32 v[108:109], v[108:109], v[6:7] op_sel_hi:[1,0]
    v_pk_mul_f32 v[110:111], v[110:111], v[6:7] op_sel_hi:[1,0]
    v_pk_mul_f32 v[112:113], v[112:113], v[6:7] op_sel_hi:[1,0]
    v_pk_mul_f32 v[114:115], v[114:115], v[6:7] op_sel_hi:[1,0]
    v_pk_mul_f32 v[116:117], v[116:117], v[6:7] op_sel_hi:[1,0]
    v_pk_mul_f32 v[118:119], v[118:119], v[6:7] op_sel_hi:[1,0]
    v_pk_mul_f32 v[120:121], v[120:121], v[6:7] op_sel_hi:[1,0]
    v_pk_mul_f32 v[122:123], v[122:123], v[6:7] op_sel_hi:[1,0]
    v_pk_mul_f32 v[124:125], v[124:125], v[6:7] op_sel_hi:[1,0]
    v_pk_mul_f32 v[126:127], v[126:127], v[6:7] op_sel_hi:[1,0]
    s_waitcnt lgkmcnt(0)
    s_branch L_pvtile
L_pvdone:
    v_accvgpr_read_b32 v10, a0
    v_lshlrev_b32 v2, 4, v0
    v_lshlrev_b32 v3, 3, v0
    ds_read_b64 v[32:33], v10 offset:0
    ds_read_b64 v[34:35], v10 offset:1024
    ds_read_b64 v[36:37], v10 offset:2048
    v_mov_b32 v5, 103424
    ds_read_b64 v[6:7], v5
    v_lshl_add_u32 v4, v0, 3, s44
    s_cmp_eq_u32 s39, 0
    s_cbranch_scc1 L_own
    s_nop 0
    v_cvt_pk_bf16_f32 v40, v96, v112
    v_cvt_pk_bf16_f32 v41, v97, v113
    v_cvt_pk_bf16_f32 v42, v98, v114
    v_cvt_pk_bf16_f32 v43, v99, v115
    buffer_store_dwordx4 v[40:43], v2, s[24:27], 0 offen offset:0 sc1
    v_cvt_pk_bf16_f32 v44, v100, v116
    v_cvt_pk_bf16_f32 v45, v101, v117
    v_cvt_pk_bf16_f32 v46, v102, v118
    v_cvt_pk_bf16_f32 v47, v103, v119
    buffer_store_dwordx4 v[44:47], v2, s[24:27], 0 offen offset:1024 sc1
    v_cvt_pk_bf16_f32 v48, v104, v120
    v_cvt_pk_bf16_f32 v49, v105, v121
    v_cvt_pk_bf16_f32 v50, v106, v122
    v_cvt_pk_bf16_f32 v51, v107, v123
    buffer_store_dwordx4 v[48:51], v2, s[24:27], 0 offen offset:2048 sc1
    v_cvt_pk_bf16_f32 v52, v108, v124
    v_cvt_pk_bf16_f32 v53, v109, v125
    v_cvt_pk_bf16_f32 v54, v110, v126
    v_cvt_pk_bf16_f32 v55, v111, v127
    buffer_store_dwordx4 v[52:55], v2, s[24:27], 0 offen offset:3072 sc1
    s_waitcnt lgkmcnt(0)
    v_sub_f32 v34, v34, v32
    v_sub_f32 v36, v36, v32
    v_exp_f32 v34, v34
    v_exp_f32 v36, v36
    s_nop 0
    v_fmac_f32 v33, v35, v34
    v_fmac_f32 v33, v37, v36
    s_movk_i32 s47, 0x1000
    buffer_store_dwordx2 v[32:33], v3, s[24:27], s47 offen sc1
    v_lshlrev_b32 v8, 7, v0
    s_barrier
    s_waitcnt vmcnt(0)
    s_mov_b64 exec, 0xffff
    global_store_dwordx2 v4, v[6:7], s[22:23] offset:512
    s_mov_b64 exec, -1
    buffer_load_dword v9, v8, s[24:27], 0 offen sc1
    s_mov_b64 exec, 0xffff
    global_store_dwordx2 v4, v[6:7], s[22:23] sc1
    s_mov_b64 exec, -1
    s_branch L_fin
L_own:
    v_add_u32 v3, 102912, v3
    s_waitcnt lgkmcnt(0)
    v_sub_f32 v34, v34, v32
    v_sub_f32 v36, v36, v32
    v_exp_f32 v34, v34
    v_exp_f32 v36, v36
    s_nop 0
    v_fmac_f32 v33, v35, v34
    v_fmac_f32 v33, v37, v36
    ds_write_b64 v3, v[32:33]
    ds_write_b128 v2, v[96:99] offset:0
    ds_write_b128 v2, v[100:103] offset:1024
    ds_write_b128 v2, v[104:107] offset:2048
    ds_write_b128 v2, v[108:111] offset:3072
    ds_write_b128 v2, v[112:115] offset:4096
    ds_write_b128 v2, v[116:119] offset:5120
    ds_write_b128 v2, v[120:123] offset:6144
    ds_write_b128 v2, v[124:127] offset:7168
    s_waitcnt lgkmcnt(0)
    s_barrier
    s_lshl_b32 s42, s40, 10
    s_add_u32 s42, s42, 9437184
    v_mov_b32 v28, v6
    v_mov_b32 v29, v7
    v_lshl_add_u32 v7, v0, 7, s42
    v_mov_b32 v26, 103424
    s_lshl_b32 s48, 1, s43
    s_xor_b32 s48, s48, 15
    s_mov_b32 s49, 40
L_lazy:
    ds_read_b32 v27, v26 offset:8
    s_waitcnt lgkmcnt(0)
    v_readfirstlane_b32 s47, v27
    s_sub_u32 s49, s49, 1
    s_cbranch_scc1 L_lazyd
    s_cmp_eq_u32 s47, 0
    s_cbranch_scc1 L_lazy
    s_branch L_fin
L_lazyd:
    s_mov_b32 s49, 0x100000
    s_mov_b32 exec_lo, s48
    s_mov_b32 exec_hi, 0
L_poll2:
    global_load_dwordx2 v[30:31], v7, s[22:23] sc1
    ds_read_b32 v27, v26 offset:8
    s_waitcnt vmcnt(0) lgkmcnt(0)
    v_cmp_eq_u64 vcc, v[28:29], v[30:31]
    v_readfirstlane_b32 s47, v27
    s_sub_u32 s49, s49, 1
    s_cbranch_scc1 L_poll2_go
    s_cmp_eq_u32 vcc_lo, s48
    s_cbranch_scc1 L_poll2_go
    s_cmp_eq_u32 s47, 0
    s_cbranch_scc1 L_poll2
L_poll2_go:
    ds_write_b32 v26, v26 offset:8
    s_mov_b64 exec, -1
    s_branch L_fin
L_recv:
    v_mbcnt_lo_u32_b32 v0, -1, 0
    v_mbcnt_hi_u32_b32 v0, -1, v0
    s_and_b32 s43, s40, 3
    s_mul_i32 s42, s40, 13824
    s_add_u32 s24, s22, s42
    s_addc_u32 s25, s23, 0
    s_and_b32 s25, s25, 0xffff
    s_mov_b32 s26, 13824
    s_mov_b32 s27, 0x20000
    s_lshl_b32 s42, s41, 14
    s_lshr_b32 s56, s43, 1
    s_lshl_b32 s56, s56, 13
    s_add_u32 s42, s42, s56
    s_add_u32 s32, s18, s42
    s_addc_u32 s33, s19, 0
    s_and_b32 s33, s33, 0xffff
    s_mov_b32 s34, 8192
    s_mov_b32 s35, 0x20000
    s_and_b32 s56, s43, 1
    s_lshl_b32 s56, s56, 7
    s_lshl_b32 s47, s3, 5
    s_add_u32 s56, s56, s47
    v_and_b32 v4, 31, v0
    v_lshlrev_b32 v4, 8, v4
    v_lshrrev_b32 v3, 5, v0
    v_lshl_or_b32 v4, v3, 4, v4
    s_lshl_b32 s42, s40, 10
    s_add_u32 s42, s42, 9437696
    v_lshl_add_u32 v7, v0, 7, s42
    v_lshlrev_b32 v5, 3, v0
    v_add_u32 v1, 102912, v5
    v_add_u32 v5, 4096, v5
    s_lshl_b32 s47, s3, 10
    v_lshl_add_u32 v2, v0, 4, s47
    s_mov_b32 s51, 0
    s_mov_b32 s52, 4608
    s_mov_b32 s53, 9216
    s_mov_b32 s54, 0xffff0000
    s_lshl_b32 s48, 1, s43
    s_xor_b32 s48, s48, 15
    s_mov_b32 s49, 0x100000
    v_mov_b32 v26, 103424
    ds_read_b64 v[28:29], v26
    s_waitcnt lgkmcnt(0)
L_rend:
    s_cmp_ge_u32 s45, 128
    s_cbranch_scc1 L_rend_d
    s_barrier
    s_add_u32 s45, s45, 1
    s_branch L_rend
L_rend_d:
    s_barrier
    ds_read_b64 v[14:15], v1
    ds_read_b128 v[32:35], v2 offset:0
    ds_read_b128 v[36:39], v2 offset:4096
    s_cmp_eq_u32 s3, 1
    s_cbranch_scc1 L_poller
L_gowait:
    ds_read_b32 v27, v26 offset:8
    s_waitcnt lgkmcnt(0)
    v_readfirstlane_b32 s47, v27
    s_nop 0
    s_cmp_eq_u32 s47, 0
    s_cbranch_scc1 L_gowait
    s_branch L_final
L_poller:
    s_mov_b32 exec_lo, s48
    s_mov_b32 exec_hi, 0
L_poll:
    global_load_dwordx2 v[30:31], v7, s[22:23] sc1
    ds_read_b32 v27, v26 offset:8
    s_waitcnt vmcnt(0) lgkmcnt(0)
    v_cmp_eq_u64 vcc, v[28:29], v[30:31]
    v_readfirstlane_b32 s47, v27
    s_sub_u32 s49, s49, 1
    s_cbranch_scc1 L_poll_go
    s_cmp_eq_u32 vcc_lo, s48
    s_cbranch_scc1 L_poll_go
    s_cmp_eq_u32 s47, 0
    s_cbranch_scc1 L_poll
L_poll_go:
    ds_write_b32 v26, v26 offset:8
L_final:
    s_mov_b64 exec, -1
    buffer_load_dwordx2 v[8:9], v5, s[24:27], s51 offen sc1
    buffer_load_dwordx2 v[10:11], v5, s[24:27], s52 offen sc1
    buffer_load_dwordx2 v[12:13], v5, s[24:27], s53 offen sc1
    buffer_load_dwordx4 v[40:43], v2, s[24:27], s51 offen sc1
    buffer_load_dwordx4 v[44:47], v2, s[24:27], s52 offen sc1
    buffer_load_dwordx4 v[48:51], v2, s[24:27], s53 offen sc1
    s_waitcnt vmcnt(3) lgkmcnt(0)
    v_max3_f32 v24, v8, v10, v12
    v_max_f32 v24, v24, v14
    v_sub_f32 v16, v14, v24
    v_sub_f32 v18, v8, v24
    v_sub_f32 v20, v10, v24
    v_sub_f32 v22, v12, v24
    v_exp_f32 v16, v16
    v_exp_f32 v18, v18
    v_exp_f32 v20, v20
    v_exp_f32 v22, v22
    s_nop 0
    v_mul_f32 v25, v15, v16
    v_fmac_f32 v25, v9, v18
    v_fmac_f32 v25, v11, v20
    v_fmac_f32 v25, v13, v22
    v_rcp_f32 v26, v25
    v_pk_mul_f32 v[32:33], v[32:33], v[16:17] op_sel_hi:[1,0]
    v_pk_mul_f32 v[34:35], v[34:35], v[16:17] op_sel_hi:[1,0]
    v_pk_mul_f32 v[36:37], v[36:37], v[16:17] op_sel_hi:[1,0]
    v_pk_mul_f32 v[38:39], v[38:39], v[16:17] op_sel_hi:[1,0]
    s_waitcnt vmcnt(2)
    v_lshlrev_b32 v56, 16, v40
    v_and_b32 v60, s54, v40
    v_lshlrev_b32 v57, 16, v41
    v_and_b32 v61, s54, v41
    v_lshlrev_b32 v58, 16, v42
    v_and_b32 v62, s54, v42
    v_lshlrev_b32 v59, 16, v43
    v_and_b32 v63, s54, v43
    v_pk_fma_f32 v[32:33], v[56:57], v[18:19], v[32:33] op_sel_hi:[1,0,1]
    v_pk_fma_f32 v[34:35], v[58:59], v[18:19], v[34:35] op_sel_hi:[1,0,1]
    v_pk_fma_f32 v[36:37], v[60:61], v[18:19], v[36:37] op_sel_hi:[1,0,1]
    v_pk_fma_f32 v[38:39], v[62:63], v[18:19], v[38:39] op_sel_hi:[1,0,1]
    s_waitcnt vmcnt(1)
    v_lshlrev_b32 v56, 16, v44
    v_and_b32 v60, s54, v44
    v_lshlrev_b32 v57, 16, v45
    v_and_b32 v61, s54, v45
    v_lshlrev_b32 v58, 16, v46
    v_and_b32 v62, s54, v46
    v_lshlrev_b32 v59, 16, v47
    v_and_b32 v63, s54, v47
    v_pk_fma_f32 v[32:33], v[56:57], v[20:21], v[32:33] op_sel_hi:[1,0,1]
    v_pk_fma_f32 v[34:35], v[58:59], v[20:21], v[34:35] op_sel_hi:[1,0,1]
    v_pk_fma_f32 v[36:37], v[60:61], v[20:21], v[36:37] op_sel_hi:[1,0,1]
    v_pk_fma_f32 v[38:39], v[62:63], v[20:21], v[38:39] op_sel_hi:[1,0,1]
    s_waitcnt vmcnt(0)
    v_lshlrev_b32 v56, 16, v48
    v_and_b32 v60, s54, v48
    v_lshlrev_b32 v57, 16, v49
    v_and_b32 v61, s54, v49
    v_lshlrev_b32 v58, 16, v50
    v_and_b32 v62, s54, v50
    v_lshlrev_b32 v59, 16, v51
    v_and_b32 v63, s54, v51
    v_pk_fma_f32 v[32:33], v[56:57], v[22:23], v[32:33] op_sel_hi:[1,0,1]
    v_pk_fma_f32 v[34:35], v[58:59], v[22:23], v[34:35] op_sel_hi:[1,0,1]
    v_pk_fma_f32 v[36:37], v[60:61], v[22:23], v[36:37] op_sel_hi:[1,0,1]
    v_pk_fma_f32 v[38:39], v[62:63], v[22:23], v[38:39] op_sel_hi:[1,0,1]
    v_pk_mul_f32 v[32:33], v[32:33], v[26:27] op_sel_hi:[1,0]
    v_pk_mul_f32 v[34:35], v[34:35], v[26:27] op_sel_hi:[1,0]
    v_pk_mul_f32 v[36:37], v[36:37], v[26:27] op_sel_hi:[1,0]
    v_pk_mul_f32 v[38:39], v[38:39], v[26:27] op_sel_hi:[1,0]
    v_cvt_pk_bf16_f32 v52, v32, v36
    v_cvt_pk_bf16_f32 v53, v33, v37
    v_cvt_pk_bf16_f32 v54, v34, v38
    v_cvt_pk_bf16_f32 v55, v35, v39
    buffer_store_dwordx4 v[52:55], v4, s[32:35], s56 offen
L_fin:
L_end:
    s_endpgm
.section .rodata,"a"
.p2align 6
.amdhsa_kernel standalone__kv_cache_quant_int4_int2_kv_with_per_channel_or_per_token_scales__sampling_kernel
  .amdhsa_next_free_vgpr 240
  .amdhsa_next_free_sgpr 96
  .amdhsa_accum_offset 136
  .amdhsa_group_segment_fixed_size 0
  .amdhsa_kernarg_size 80
  .amdhsa_user_sgpr_count 2
  .amdhsa_user_sgpr_kernarg_segment_ptr 1
  .amdhsa_system_sgpr_workgroup_id_x 1
  .amdhsa_float_denorm_mode_32 3
  .amdhsa_float_denorm_mode_16_64 3
.end_amdhsa_kernel
```
